```python
import torch

def _softmax(x, axis=-1):
    return torch.softmax(x, dim=axis)
def _gelu(x):
    return torch.nn.functional.gelu(x, approximate="tanh")
def _silu(x):
    return torch.nn.functional.silu(x)
def _sigmoid(x):
    return torch.sigmoid(x)
def _layernorm(x, axis=-1, eps=1e-5):
    m = x.mean(dim=axis, keepdim=True)
    v = x.var(dim=axis, keepdim=True, unbiased=False)
    return (x - m) / torch.sqrt(v + eps)
def _scatter_add(tgt, idx, src, axis=0):
    return tgt.clone().index_add_(axis, idx, src)
def _segment_sum(src, seg, n):
    out = torch.zeros((n,) + src.shape[1:], dtype=src.dtype)
    return out.index_add_(0, seg, src)
def _pad(x, pw):
    flat = tuple(v for pair in reversed(pw) for v in pair)
    return torch.nn.functional.pad(x, flat)

kernel_name = 'interleave_layers__mha_block_cached__glu_gated_swiglu__decode'

def setup_inputs():

    _w = (lambda a: (lambda t: t.to(torch.bfloat16) if t.is_floating_point() else t)(torch.as_tensor(a)))
    def _A_setup():
        B, Sq, D = 1, 1, 640
        H, Sk, Dh = 32, 4096, 128
        return {
            "x": _w((lambda *s: torch.randn(*s, dtype=torch.bfloat16) * 0.05)(B, Sq, D)),
            "k_cache": _w((lambda *s: torch.randn(*s, dtype=torch.bfloat16) * 0.8)(B, H, Sk, Dh)),
            "v_cache": _w((lambda *s: torch.randn(*s, dtype=torch.bfloat16) * 0.8)(B, H, Sk, Dh)),
            "wq": _w((lambda *s: torch.randn(*s, dtype=torch.bfloat16) * 0.8)(D, H * Dh) * (D ** -0.5)),
            "wo": _w((lambda *s: torch.randn(*s, dtype=torch.bfloat16) * 0.8)(H * Dh, D) * ((H * Dh) ** -0.5)),
        }
    _A_in = _A_setup()

    def _B_setup():
        B, S, D, F = 1, 1, 640, 1728
        return {
            "x": _w((lambda *s: torch.randn(*s, dtype=torch.bfloat16) * 0.05)(B, S, D)),
            "w1": _w((lambda *s: torch.randn(*s, dtype=torch.bfloat16) * 0.2)(D, F) * (2.0 / D) ** 0.5),
            "w3": _w((lambda *s: torch.randn(*s, dtype=torch.bfloat16) * 0.2)(D, F) * (2.0 / D) ** 0.5),
            "w2": _w((lambda *s: torch.randn(*s, dtype=torch.bfloat16) * 0.2)(F, D) * (2.0 / F) ** 0.5),
        }
    _B_in = _B_setup()

    return {
        "A_x": _A_in["x"],
        "A_k_cache": _A_in["k_cache"],
        "A_v_cache": _A_in["v_cache"],
        "A_wq": _A_in["wq"],
        "A_wo": _A_in["wo"],
        "B_x": _B_in["x"],
        "B_w1": _B_in["w1"],
        "B_w3": _B_in["w3"],
        "B_w2": _B_in["w2"],
    }

def reference(A_x, A_k_cache, A_v_cache, A_wq, A_wo, B_x, B_w1, B_w3, B_w2):
    def _A_ref(x, k_cache, v_cache, wq, wo):
        B, Sq, D = x.shape
        H, Dh = 32, 128
        q = (lambda x, *d: x.permute(*d))((x @ wq).reshape(B, Sq, H, Dh), 0, 2, 1, 3)
        scores = torch.einsum("bhqd,bhkd->bhqk", q, k_cache) * (Dh ** -0.5)
        p = _softmax(scores, axis=-1)
        o = torch.einsum("bhqk,bhkd->bhqd", p, v_cache)
        return (lambda x, *d: x.permute(*d))(o, 0, 2, 1, 3).reshape(B, Sq, H * Dh) @ wo

    def _B_ref(x, w1, w3, w2):
        gate = torch.einsum("bsd,df->bsf", x, w1)
        up = torch.einsum("bsd,df->bsf", x, w3)
        h = _silu(gate) * up
        out = torch.einsum("bsf,fd->bsd", h, w2)
        return out

    x = A_x
    x = x + _A_ref(_layernorm(x, axis=-1), A_k_cache, A_v_cache, A_wq, A_wo)
    x = x + _B_ref(_layernorm(x, axis=-1), B_w1, B_w3, B_w2)
    x = x + _A_ref(_layernorm(x, axis=-1), A_k_cache, A_v_cache, A_wq, A_wo)
    x = x + _B_ref(_layernorm(x, axis=-1), B_w1, B_w3, B_w2)
    return x
```

```asm
; @launch grid=(256,1,1) block=(512,1,1) lds=132096
.amdgcn_target "amdgcn-amd-amdhsa--gfx950"
.text
.globl interleave_layers__mha_block_cached__glu_gated_swiglu__decode_kernel
.p2align 8
.type interleave_layers__mha_block_cached__glu_gated_swiglu__decode_kernel,@function
interleave_layers__mha_block_cached__glu_gated_swiglu__decode_kernel:
    s_cmpk_ge_u32 s2, 256
    s_cbranch_scc1 L_exit
    s_load_dwordx2 s[64:65], s[0:1], 16
    s_load_dwordx8 s[52:59], s[0:1], 64
    s_load_dwordx16 s[36:51], s[0:1], 0
    v_readfirstlane_b32 s33, v0
    s_and_b32 s3, s2, 7
    s_lshr_b32 s6, s2, 6
    s_lshl2_add_u32 s6, s3, s6
    s_lshl_b32 s8, s6, 20
    s_mov_b32 s67, 0x20000
    s_lshl_b32 s66, s67, 8
    s_and_b32 s13, s2, 16
    s_mul_i32 s13, s13, 6
    s_and_b32 s14, s2, 32
    s_mul_i32 s14, s14, 33
    s_xor_b32 s13, s13, s14
    s_and_b32 s14, s33, 64
    s_mul_i32 s14, s14, 5
    s_xor_b32 s13, s13, s14
    s_lshr_b32 s14, s33, 3
    s_and_b32 s14, s14, 16
    s_xor_b32 s13, s13, s14
    s_or_b32 s14, s33, s2
    s_lshr_b32 s14, s14, 2
    s_and_b32 s14, s14, 0x42
    s_xor_b32 s35, s13, s14
    v_and_b32 v15, 32, v0
    v_lshl_add_u32 v15, v15, 6, v15
    v_and_b32 v14, 16, v0
    v_lshl_add_u32 v15, v14, 3, v15
    v_xor_b32 v13, s35, v15
    v_lshlrev_b32 v13, 4, v13
    v_and_or_b32 v13, v0, 15, v13
    v_lshlrev_b32 v13, 4, v13
    s_waitcnt lgkmcnt(0)
    buffer_load_dwordx4 v[192:195], v13, s[64:67], s8 offen offset:0 nt
    buffer_load_dwordx4 v[196:199], v13, s[64:67], s8 offen offset:256 nt
    s_lshr_b32 s5, s33, 6
    s_lshr_b32 s13, s2, 4
    s_lshl3_add_u32 s13, s13, s3
    s_andn2_b32 s14, 8, s2
    s_or_b32 s14, s14, s33
    s_lshl4_add_u32 s33, s14, s13
    s_cmp_lt_u32 s33, 45
    s_cbranch_scc1 L_clear
L_noclear:
    s_lshr_b32 s4, s2, 3
    s_getpc_b64 s[26:27]
L_pc:
    s_sub_u32 s26, s26, L_pc-interleave_layers__mha_block_cached__glu_gated_swiglu__decode_kernel
    s_subb_u32 s27, s27, 0
    v_and_b32 v19, 3, v0
    s_lshl_b32 s28, s4, 7
    v_lshl_add_u32 v19, v19, 12, s28
    v_min_u32 v19, L_code_end-interleave_layers__mha_block_cached__glu_gated_swiglu__decode_kernel-4, v19
    s_cmp_eq_u32 s5, 1
    s_cbranch_scc0 L_nocpf
    global_load_dword v31, v19, s[26:27]
L_nocpf:
    v_lshlrev_b32 v5, 2, v0
    v_and_b32 v0, 63, v0
    s_and_b32 s7, s4, 7
    v_and_b32 v14, 15, v0
    v_lshrrev_b32 v15, 4, v0
    v_and_b32 v17, 6, v0
    v_and_or_b32 v12, v0, 1, s35
    v_lshl_add_u32 v12, v17, 1, v12
    v_and_b32 v17, 8, v0
    v_lshl_add_u32 v12, v17, 4, v12
    v_lshl_add_u32 v12, v12, 4, v15
    v_lshlrev_b32 v12, 4, v12
    v_lshlrev_b32 v30, 4, v0
    v_lshrrev_b32 v18, 3, v0
    v_mul_u32_u24 v18, 8192, v18
    v_and_b32 v28, 0x70, v30
    v_and_b32 v29, 32, v0
    v_xor_b32 v28, v28, v29
    s_and_b32 s13, s5, 1
    s_lshl_b32 s13, s13, 6
    v_xor_b32 v28, s13, v28
    v_add_u32 v18, v18, v28
    s_lshr_b32 s14, s7, 1
    s_mul_i32 s14, s14, 1310720
    s_lshl_b32 s15, s5, 16
    s_add_u32 s14, s14, s15
    s_lshl_b32 s15, s6, 8
    s_add_u32 s14, s14, s15
    s_and_b32 s15, s7, 1
    s_lshl_b32 s15, s15, 7
    s_add_u32 s14, s14, s15
    s_lshl_b32 s15, s5, 10
    s_mov_b32 s86, 1280
    s_mov_b32 s87, 0x20000
    s_mov_b32 s74, 5242880
    s_mov_b32 s75, 0x20000
    s_mov_b32 s70, 368640
    s_mov_b32 s71, 0x20000
    s_mov_b32 s62, 33554432
    s_mov_b32 s63, 0x20000
    s_setprio 3
    s_mov_b64 s[84:85], s[36:37]
    s_mov_b64 s[72:73], s[42:43]
    s_mov_b64 s[68:69], s[58:59]
    s_mov_b64 s[60:61], s[38:39]
    s_cmp_lt_u32 s33, 45
    s_cbranch_scc1 L_keep
    buffer_load_dword v4, v5, s[84:87], 0 offen
    s_cmp_eq_u32 s5, 0
    s_cbranch_scc1 L_wq_done
    v_xor_b32 v19, 64, v18
    s_add_u32 m0, s15, 16384
    s_sub_u32 s14, s14, 65536
    buffer_load_dwordx4 v19, s[72:75], s14 offen nt lds
    s_add_u32 m0, s15, 23552
    s_add_u32 s14, s14, 458752
    buffer_load_dwordx4 v18, s[72:75], s14 offen nt lds
    s_cmp_lt_u32 s5, 7
    s_cbranch_scc0 L_wq_done
    s_add_u32 m0, s15, 30720
    s_add_u32 s14, s14, 458752
    buffer_load_dwordx4 v19, s[72:75], s14 offen nt lds
L_wq_done:
    s_setprio 0
L_keep:
    v_xor_b32 v21, 532480, v12
    buffer_load_dwordx4 v[64:67], v12, s[60:63], s8 offen offset:0 nt
    buffer_load_dwordx4 v[68:71], v12, s[60:63], s8 offen offset:64 nt
    buffer_load_dwordx4 v[72:75], v12, s[60:63], s8 offen offset:128 nt
    buffer_load_dwordx4 v[76:79], v12, s[60:63], s8 offen offset:192 nt
    buffer_load_dwordx4 v[200:203], v13, s[64:67], s8 offen offset:1024 nt
    buffer_load_dwordx4 v[204:207], v13, s[64:67], s8 offen offset:1280 nt
    buffer_load_dwordx4 v[208:211], v13, s[64:67], s8 offen offset:2048 nt
    buffer_load_dwordx4 v[212:215], v13, s[64:67], s8 offen offset:2304 nt
    buffer_load_dwordx4 v[80:83], v21, s[60:63], s8 offen offset:0 nt
    buffer_load_dwordx4 v[84:87], v21, s[60:63], s8 offen offset:64 nt
    buffer_load_dwordx4 v[88:91], v21, s[60:63], s8 offen offset:128 nt
    buffer_load_dwordx4 v[92:95], v21, s[60:63], s8 offen offset:192 nt
    s_branch L_nob1
L_clear:
    v_lshlrev_b32 v18, 2, v0
    global_load_dword v4, v18, s[36:37]
    v_mov_b32 v24, -1
    v_mov_b32 v25, -1
    v_mov_b32 v26, -1
    v_mov_b32 v27, -1
    s_mul_i32 s14, s33, 8192
    v_lshl_add_u32 v18, v0, 4, s14
    v_add_u32 v19, 4096, v18
    s_lshl_b32 s13, s33, 7
    s_add_u32 s13, s13, 393216
    v_and_b32 v22, 32, v0
    v_and_b32 v23, 31, v0
    v_lshl_add_u32 v22, v22, 8, s13
    v_lshl_add_u32 v22, v23, 2, v22
    global_store_dword v22, v24, s[58:59] sc1
    global_store_dwordx4 v19, v[24:27], s[58:59] offset:-4096 sc1
    global_store_dwordx4 v19, v[24:27], s[58:59] offset:-3072 sc1
    global_store_dwordx4 v19, v[24:27], s[58:59] offset:-2048 sc1
    global_store_dwordx4 v19, v[24:27], s[58:59] offset:-1024 sc1
    global_store_dwordx4 v19, v[24:27], s[58:59] offset:0 sc1
    global_store_dwordx4 v19, v[24:27], s[58:59] offset:1024 sc1
    global_store_dwordx4 v19, v[24:27], s[58:59] offset:2048 sc1
    global_store_dwordx4 v19, v[24:27], s[58:59] offset:3072 sc1
    s_bfe_u32 s31, s33, 0x10003
    s_lshl_b32 s16, s31, 13
    s_add_u32 s13, s13, s16
    s_xor_b32 s16, s13, 8192
.p2align 5
    s_waitcnt vmcnt(8)
    s_load_dword s30, s[58:59], s13
    s_load_dwordx2 s[28:29], s[58:59], s16
    s_waitcnt lgkmcnt(2)
    s_getreg_b32 s32, hwreg(HW_REG_IB_STS, 8, 4)
    s_getreg_b32 s13, hwreg(HW_REG_XCC_ID, 2, 1)
    s_lshr_b32 s26, s32, 1
    s_xnor_b32 s26, s26, s31
    s_xor_b32 s26, s26, s13
    s_and_b32 s26, s26, 1
    s_lshl_b32 s26, s26, 16
    s_or_b32 s26, s26, 1
    s_waitcnt vmcnt(0)
    s_mov_b32 s27, s26
    s_atomic_add s26, s[56:57], 0 glc
    s_waitcnt lgkmcnt(0)
    s_add_u32 s26, s26, s27
    s_and_b32 s27, s26, 0xffff
    s_cmp_eq_u32 s27, 45
    s_cbranch_scc0 L_noclear
    s_atomic_add s26, s[56:57], 128
    s_atomic_add s26, s[56:57], 192
    s_atomic_add s26, s[56:57], 64
    s_waitcnt lgkmcnt(0)
    s_branch L_noclear
L_nob1:
    s_mov_b64 s[76:77], s[44:45]
    s_mov_b32 s78, 5242880
    s_mov_b32 s79, 0x20000
    s_mov_b64 s[80:81], s[52:53]
    s_mov_b32 s82, 2211840
    s_mov_b32 s83, 0x20000
    s_mov_b64 s[88:89], s[54:55]
    s_mov_b32 s90, 1280
    s_mov_b32 s91, 0x20000
    s_mov_b64 s[92:93], s[48:49]
    s_mov_b32 s94, 2211840
    s_mov_b32 s95, 0x20000
    s_mov_b32 s12, 0x200000
    s_mov_b32 s9, 0
    s_mov_b32 s10, 0
    s_mov_b32 s11, 0
    s_mov_b32 s46, 0
    s_mov_b32 s17, 0x05040100
    s_mov_b32 s18, 0x07060302
    s_mov_b32 s24, 0xffff0000
    s_cmp_eq_u32 s3, 7
    s_cselect_b32 s47, 64, 192
    s_mov_b32 s25, 2
    s_mov_b32 s41, 31
    v_and_b32 v20, 3, v0
    v_lshlrev_b32 v2, 6, v15
    v_lshl_add_u32 v2, v20, 4, v2
    v_and_b32 v1, 8, v0
    v_bfe_u32 v23, v0, 4, 1
    v_lshl_add_u32 v1, v23, 2, v1
    v_bfe_u32 v23, v0, 2, 1
    v_add_u32 v1, v1, v23
    v_and_b32 v17, 1, v0
    v_mul_u32_u24 v3, 0xaaaa, v17
    v_bfe_u32 v23, v0, 1, 1
    v_mul_u32_u24 v23, 0xaaaa, v23
    v_lshl_add_u32 v3, v23, 16, v3
    v_add_u32 v3, 0x44444444, v3
    v_lshl_add_u32 v6, v0, 3, 64
    s_lshl_b32 s13, s5, 3
    v_writelane_b32 v6, s13, 63
    s_mov_b32 s98, 0x3f803f80
    v_mov_b32 v44, 2130706432
    v_mov_b32 v45, v5
    v_lshlrev_b32 v46, 1, v5
    v_mov_b32 v16, 0
    v_lshlrev_b32 v17, 2, v14
    ds_write_b32 v17, v16 offset:14464
    v_mov_b32 v19, 0x3f803f80
    v_min_u32 v20, 1276, v5
    ds_write_b32 v20, v19 offset:15616
    v_mov_b32 v25, 2130706432
    v_mov_b32 v26, 2130706432
    v_mov_b32 v24, 2130706432
    v_mov_b32 v27, 2130706432
    v_mov_b32 v254, 2130706432
    s_cmp_eq_u32 s5, 0
    s_cbranch_scc0 L_noarr
    v_mov_b32 v29, -1
    ds_write_b32 v30, v29 offset:14528
    ds_write_b32 v16, v29 offset:15556
    s_setprio 1
L_noarr:
    s_waitcnt vmcnt(12)
    s_cmp_lt_u32 s5, 5
    s_cbranch_scc0 L_barA
    ds_write_b32 v45, v4 offset:2048
    v_lshlrev_b32 v40, 16, v4
    v_and_b32 v41, s24, v4
    v_mul_f32 v43, v40, v40
    v_add_f32 v42, v40, v41
    v_fmac_f32 v43, v41, v41
    ds_write_b64 v46, v[42:43] offset:4608
L_barA:
    s_waitcnt lgkmcnt(0)
    s_cmp_ge_u32 s5, 4
    s_barrier
    s_cbranch_scc1 L_q_prep0
L_stream:
    s_lshl_b32 s22, s6, 10
    s_add_u32 s22, s22, 294912
    v_xor_b32 v14, 532480, v12
    v_xor_b32 v15, 131072, v12
    v_xor_b32 v16, 663552, v12
    v_xor_b32 v17, 131072, v13
    buffer_load_dwordx4 v[96:99], v15, s[60:63], s8 offen offset:0 nt
    buffer_load_dwordx4 v[100:103], v15, s[60:63], s8 offen offset:64 nt
    buffer_load_dwordx4 v[104:107], v15, s[60:63], s8 offen offset:128 nt
    buffer_load_dwordx4 v[108:111], v15, s[60:63], s8 offen offset:192 nt
    v_mov_b32 v29, 0
    buffer_load_dwordx4 v[112:115], v16, s[60:63], s8 offen offset:0 nt
    buffer_load_dwordx4 v[116:119], v16, s[60:63], s8 offen offset:64 nt
    buffer_load_dwordx4 v[120:123], v16, s[60:63], s8 offen offset:128 nt
    buffer_load_dwordx4 v[124:127], v16, s[60:63], s8 offen offset:192 nt
    v_mov_b32 v29, 0
    buffer_load_dwordx4 v[216:219], v13, s[64:67], s8 offen offset:3072 nt
    buffer_load_dwordx4 v[220:223], v13, s[64:67], s8 offen offset:3328 nt
    v_mov_b32 v29, 0
    buffer_load_dwordx4 v[224:227], v17, s[64:67], s8 offen offset:0 nt
    buffer_load_dwordx4 v[228:231], v17, s[64:67], s8 offen offset:256 nt
    buffer_load_dwordx4 v[232:235], v17, s[64:67], s8 offen offset:1024 nt
    buffer_load_dwordx4 v[236:239], v17, s[64:67], s8 offen offset:1280 nt
    v_mov_b32 v29, 0
    buffer_load_dwordx4 v[240:243], v17, s[64:67], s8 offen offset:2048 nt
    buffer_load_dwordx4 v[244:247], v17, s[64:67], s8 offen offset:2304 nt
    buffer_load_dwordx4 v[248:251], v17, s[64:67], s8 offen offset:3072 nt
    buffer_load_dwordx4 v[252:255], v17, s[64:67], s8 offen offset:3328 nt
    s_setprio 0
    v_lshlrev_b32 v12, 3, v0
    v_mov_b32 v29, 0
    s_cmp_lt_u32 s5, 4
    s_cbranch_scc0 L_barW
    s_cmp_eq_u32 s5, 0
    s_cbranch_scc0 L_nostage
    s_waitcnt vmcnt(40)
    s_load_dword s26, s[56:57], 128
    s_waitcnt lgkmcnt(0)
    s_cmp_eq_u32 s26, 0
    s_cbranch_scc0 L_go_ok
    s_sub_u32 s12, s12, 1
    s_sleep 12
    s_load_dword s26, s[56:57], 192
    s_waitcnt lgkmcnt(0)
    s_cmp_eq_u32 s26, 0
    s_cbranch_scc0 L_go_ok
    s_sub_u32 s12, s12, 1
    s_sleep 12
    s_load_dword s26, s[56:57], 64
    s_waitcnt lgkmcnt(0)
    s_cmp_eq_u32 s26, 0
    s_cbranch_scc0 L_go_ok
L_go:
    s_sub_u32 s12, s12, 1
    s_cbranch_scc1 L_end
    v_mov_b32 v28, 0
    global_load_dword v28, v28, s[56:57] offset:128 sc1
    s_waitcnt vmcnt(0)
    v_readfirstlane_b32 s26, v28
    s_cmp_eq_u32 s26, 0
    s_cbranch_scc1 L_go
L_go_ok:
    v_and_b32 v15, 31, v0
    v_lshlrev_b32 v15, 5, v15
    s_lshl_b32 s14, s3, 10
    s_add_u32 s14, s14, 360448
    buffer_load_dwordx4 v[8:11], v30, s[68:71], s22 offen sc1
    buffer_load_dword v14, v15, s[68:71], s14 offen sc1
    s_branch L_q0_chk
L_q0:
    s_sub_u32 s12, s12, 1
    s_cbranch_scc1 L_end
    s_sleep 16
    buffer_load_dwordx4 v[8:11], v30, s[68:71], s22 offen sc1
    buffer_load_dword v14, v15, s[68:71], s14 offen sc1
L_q0_chk:
    s_waitcnt vmcnt(0)
    v_max3_u32 v28, v8, v9, v10
    v_max3_u32 v28, v28, v14, v11
    v_cmp_eq_u32 vcc, -1, v28
    s_cbranch_vccnz L_q0
L_q0_ok:
    s_getreg_b32 s13, hwreg(HW_REG_XCC_ID, 0, 4)
    v_cmp_ne_u32 vcc, s13, v14
    s_cmp_eq_u64 vcc, 0
    s_cselect_b32 s13, 1, 0
    s_cmp_gt_u32 s26, 1507327
    s_cselect_b32 s26, 2, 0
    s_or_b32 s13, s13, s26
    v_mov_b32 v15, s13
    v_mov_b32 v29, 0
    ds_write_b32 v29, v15 offset:15552
    ds_write_b128 v30, v[8:11] offset:14528
    s_branch L_nostage
L_barW:
    s_barrier
L_nostage:
    s_lshl_b32 s13, s5, 9
    v_lshl_add_u32 v18, v0, 5, s13
    v_and_b32 v19, 56, v12
    s_lshl_b32 s36, s6, 11
    s_lshl_b32 s13, s7, 5
    s_add_u32 s36, s36, s13
    v_lshrrev_b32 v28, 3, v0
    v_lshrrev_b32 v24, 1, v19
    v_lshl_add_u32 v24, v28, 8, v24
    v_and_b32 v28, 6, v28
    s_lshl_b32 s37, s6, 5
    s_lshl_b32 s13, s7, 2
    s_add_u32 s37, s37, s13
    s_add_u32 s37, s37, 145408
    v_add_lshl_u32 v27, v28, v0, 2
    v_lshlrev_b32 v28, 30, v0
    v_and_b32 v27, 28, v27
    v_and_b32 v28, 0x40000000, v28
    v_lshl_add_u32 v13, v0, 1, v28
    s_lshl_b32 s38, s3, 13
    s_lshl_b32 s13, s5, 10
    s_add_u32 s38, s38, s13
    s_lshl_b32 s39, s3, 7
    s_lshr_b32 s13, s5, 1
    s_lshl_b32 s13, s13, 5
    s_add_u32 s39, s39, s13
    s_add_u32 s39, s39, 145408
    v_mov_b32 v32, 0
    v_mov_b32 v33, 0
    v_mov_b32 v40, 0
    v_mov_b32 v41, 0
    v_mov_b32 v48, 0
    v_mov_b32 v49, 0
    v_mov_b32 v56, 0
    v_mov_b32 v57, 0
    s_waitcnt vmcnt(10)
L_ql:
    ds_read_b128 v[8:11], v30 offset:14528
    ds_read_b32 v15, v29 offset:15552
    s_waitcnt lgkmcnt(0)
    v_cmp_eq_u32 vcc, -1, v8
    s_cbranch_vccz L_ql_ok
    s_sub_u32 s12, s12, 1
    s_sleep 4
    s_cbranch_scc0 L_ql
    s_branch L_end
L_ql_ok:
    v_readfirstlane_b32 s11, v15
    s_getreg_b32 s84, hwreg(HW_REG_XCC_ID, 2, 1)
    s_lshr_b32 s13, s11, 1
    s_xor_b32 s84, s84, s13
    s_lshl_b32 s84, s84, 13
    s_and_b32 s11, s11, 1
    s_branch L_qpoll_ok
L_g:
    s_mul_i32 s21, s3, 1280
    s_add_u32 s21, s21, s10
    s_add_u32 s21, s21, 131072
    v_lshrrev_b32 v52, 1, v0
    v_xor_b32 v52, v52, v0
    v_and_b32 v52, 8, v52
    v_and_b32 v54, 6, v0
    v_or_b32 v52, v52, v54
    v_mov_b32 v55, 0x3f803f80
    v_cmp_eq_u32 vcc, 0, v52
    v_and_b32 v54, 1, v0
    v_mul_u32_u24 v54, 0x5555, v54
    v_cndmask_b32 v48, 0, v55, vcc
    v_cndmask_b32 v49, 0, v55, vcc
    v_cmp_eq_u32 vcc, 4, v52
    v_add_u32 v54, 0x8888, v54
    s_nop 0
    v_cndmask_b32 v50, 0, v55, vcc
    v_cndmask_b32_e64 v51, 0, v55, vcc
    s_cmp_eq_u32 s46, 0
    s_cbranch_scc0 L_g_x
    s_sub_u32 s21, s21, 147456
    buffer_load_dword v4, v5, s[68:71], s21 offen sc1
    s_branch L_xpoll_chk
.p2align 6
.fill 6, 4, 0xbf800000
L_xpoll:
    s_sub_u32 s12, s12, 1
    s_cbranch_scc1 L_end
    buffer_load_dword v4, v5, s[68:71], s21 offen sc1
L_xpoll_chk:
    s_waitcnt vmcnt(0)
    v_cmp_eq_u32 vcc, -1, v4
    s_cbranch_vccnz L_xpoll
L_xpoll_ok:
    s_branch L_g_sw
L_g_x:
    s_cmp_eq_u32 s46, 0
    s_cselect_b32 s13, 20, 10
    s_cselect_b32 s14, 4294819880, 0
    v_cmp_gt_u32 vcc, s13, v0
    s_add_u32 s14, s14, s86
    s_and_b32 s13, s4, 3
    s_lshl_b32 s13, s13, 7
    s_add_u32 s14, s14, s13
    v_lshlrev_b32 v44, 2, v0
    v_mov_b32 v47, 2130706432
    v_cndmask_b32 v44, v47, v44, vcc
    buffer_load_dword v47, v44, s[68:71], s14 offen sc1
    s_cmp_eq_u32 s9, 0
    s_cbranch_scc1 L_hook
L_fgo:
    s_branch L_fpoll_chk
.p2align 6
L_fpoll:
    s_sub_u32 s12, s12, 1
    s_cbranch_scc1 L_end
    buffer_load_dword v47, v44, s[68:71], s14 offen sc1
L_fpoll_chk:
    s_waitcnt vmcnt(0)
    v_cmp_eq_u32 vcc, -1, v47
    s_cbranch_vccnz L_fpoll
L_fpoll_ok:
L_g_sw:
    s_cmp_eq_u32 s46, 0
    s_cselect_b32 s13, 6, 7
    s_cselect_b32 s14, 63, 127
    s_cselect_b32 s15, 4294822400, 0
    s_cselect_b32 s16, 0, 1280
    v_lshrrev_b32 v53, s13, v5
    v_and_b32 v52, s14, v5
    v_lshl_add_u32 v53, v53, 7, v52
    s_add_u32 s28, s15, s10
    s_add_u32 s28, s28, 65536
    s_add_u32 s28, s28, s84
    s_sub_u32 s15, 2560, s16
    s_add_u32 s29, s28, s15
    s_add_u32 s30, s28, 16384
    s_add_u32 s31, s29, 16384
    s_add_u32 s32, s30, 16384
    s_add_u32 s33, s31, 16384
    s_add_u32 s34, s32, 16384
    s_add_u32 s35, s33, 16384
    v_add_u32 v45, s16, v5
    v_lshlrev_b32 v46, 1, v45
    buffer_load_dword v56, v53, s[68:71], s28 offen sc1
    buffer_load_dword v57, v53, s[68:71], s29 offen sc1
    buffer_load_dword v58, v53, s[68:71], s30 offen sc1
    buffer_load_dword v59, v53, s[68:71], s31 offen sc1
    buffer_load_dword v60, v53, s[68:71], s32 offen sc1
    buffer_load_dword v61, v53, s[68:71], s33 offen sc1
    buffer_load_dword v62, v53, s[68:71], s34 offen sc1
    buffer_load_dword v63, v53, s[68:71], s35 offen sc1
    v_lshlrev_b32 v40, 16, v4
    v_and_b32 v41, s24, v4
    s_branch L_ychk
.p2align 6
L_final:
    s_nop 0
    v_cvt_pk_bf16_f32 v4, v40, v41
    buffer_store_dword v4, v5, s[88:91], 0 offen
    s_endpgm
.p2align 6
.fill 2, 4, 0xbf800000
L_yretry:
    s_sub_u32 s12, s12, 1
    s_cbranch_scc1 L_end
    buffer_load_dword v56, v53, s[68:71], s28 offen sc1
    buffer_load_dword v57, v53, s[68:71], s29 offen sc1
    buffer_load_dword v58, v53, s[68:71], s30 offen sc1
    buffer_load_dword v59, v53, s[68:71], s31 offen sc1
    buffer_load_dword v60, v53, s[68:71], s32 offen sc1
    buffer_load_dword v61, v53, s[68:71], s33 offen sc1
    buffer_load_dword v62, v53, s[68:71], s34 offen sc1
    buffer_load_dword v63, v53, s[68:71], s35 offen sc1
    v_lshlrev_b32 v40, 16, v4
    v_and_b32 v41, s24, v4
L_ychk:
    s_cmp_eq_u32 s9, 2
    s_waitcnt vmcnt(0)
    v_smfmac_f32_16x16x64_bf16 v[40:43], v[48:51], v[56:63], v54
    v_max3_u32 v28, v56, v57, v58
    v_max3_u32 v29, v59, v60, v61
    v_max3_u32 v28, v28, v63, v62
    v_max_u32 v28, v28, v29
    v_cmp_eq_u32 vcc, -1, v28
    s_cbranch_vccnz L_yretry
    s_cbranch_scc1 L_final
    s_nop 0
    v_cvt_pk_bf16_f32 v4, v40, v41
    ds_write_b32 v45, v4 offset:2048
    v_lshlrev_b32 v40, 16, v4
    v_and_b32 v41, s24, v4
    v_mul_f32 v43, v40, v40
    v_add_f32 v42, v40, v41
    v_fmac_f32 v43, v41, v41
    ds_write_b64 v46, v[42:43] offset:4608
    s_cmp_eq_u32 s46, 1
    s_cbranch_scc1 L_up_m
    s_cmp_ge_u32 s5, 4
    s_cbranch_scc0 L_att1
L_q_bar:
    s_waitcnt lgkmcnt(0)
    s_barrier
L_q_go:
    ds_read_b64 v[32:33], v253 offset:4608
    ds_read_b64 v[34:35], v253 offset:5120
    ds_read_b64 v[36:37], v253 offset:5632
    ds_read_b64 v[38:39], v253 offset:6144
    ds_read_b64 v[40:41], v253 offset:6656
    ds_read_b128 v[44:47], v16 offset:2048
    ds_read_b128 v[48:51], v16 offset:2176
    ds_read_b128 v[52:55], v17 offset:2048
    v_mov_b32 v42, 1e-05
    s_cmp_eq_u32 s11, 0
    s_waitcnt lgkmcnt(4)
    v_pk_add_f32 v[32:33], v[32:33], v[34:35]
    v_pk_add_f32 v[36:37], v[36:37], v[38:39]
    s_waitcnt lgkmcnt(3)
    v_pk_add_f32 v[32:33], v[32:33], v[40:41]
    v_pk_add_f32 v[32:33], v[32:33], v[36:37]
    s_waitcnt lgkmcnt(2)
    v_smfmac_f32_16x16x64_bf16 v[248:251], v[44:47], v[224:231], v3
    v_add_f32_dpp v32, v32, v32 quad_perm:[1,0,3,2] row_mask:0xf bank_mask:0xf
    v_add_f32_dpp v33, v33, v33 quad_perm:[1,0,3,2] row_mask:0xf bank_mask:0xf
    s_waitcnt lgkmcnt(1)
    v_smfmac_f32_16x16x64_bf16 v[248:251], v[48:51], v[232:239], v3
    v_add_f32_dpp v32, v32, v32 quad_perm:[2,3,0,1] row_mask:0xf bank_mask:0xf
    v_add_f32_dpp v33, v33, v33 quad_perm:[2,3,0,1] row_mask:0xf bank_mask:0xf
    s_waitcnt lgkmcnt(0)
    v_smfmac_f32_16x16x64_bf16 v[248:251], v[52:55], v[240:247], v3
    v_add_f32_dpp v32, v32, v32 row_half_mirror row_mask:0xf bank_mask:0xf
    v_add_f32_dpp v33, v33, v33 row_half_mirror row_mask:0xf bank_mask:0xf
    s_nop 0
    v_add_f32_dpp v32, v32, v32 row_mirror row_mask:0xf bank_mask:0xf
    v_add_f32_dpp v33, v33, v33 row_mirror row_mask:0xf bank_mask:0xf
    s_nop 0
    v_add_f32_dpp v32, v32, v32 row_bcast:15 row_mask:0xa bank_mask:0xf
    v_add_f32_dpp v33, v33, v33 row_bcast:15 row_mask:0xa bank_mask:0xf
    s_nop 0
    v_add_f32_dpp v32, v32, v32 row_bcast:31 row_mask:0xc bank_mask:0xf
    v_add_f32_dpp v33, v33, v33 row_bcast:31 row_mask:0xc bank_mask:0xf
    v_mul_f32 v32, 0.0015625, v32
    v_add_f32 v252, v248, v249
    v_fmamk_f32 v33, v33, 0.0015625, v42
    v_add_f32 v248, v248, v249
    v_fma_f32 v33, -v32, v32, v33
    v_max_f32_e64 v33, v42, v33
    v_permlane16_swap_b32 v248, v252
    v_rsq_f32_e64 v33, v33
    v_readlane_b32 s13, v32, 63
    v_mul_f32 v33, 0.12751743082459868, v33
    s_nop 0
    v_fma_f32 v248, -s13, v252, v248
    v_readlane_b32 s14, v33, 63
    s_nop 0
    v_mov_b32_dpp v34, v248 quad_perm:[1,1,3,3] row_mask:0xf bank_mask:0xf
    v_mul_f32_e64 v248, s14, v248
    v_mul_f32_e64 v34, s14, v34
    v_cvt_pk_bf16_f32 v35, v248, v34
    v_min_u32_e64 v35, -2, v35
    s_cbranch_scc1 L_q_st_slow
    buffer_store_dword v35, v254, s[68:71], s23 offen
L_q_st_done:
    s_setprio 0
    s_cmp_eq_u32 s9, 0
    s_cbranch_scc1 L_stream
    s_barrier
    buffer_load_dwordx4 v[8:11], v30, s[68:71], s22 offen sc1
    v_mov_b32 v32, 0
    v_mov_b32 v33, 0
    v_mov_b32_e64 v40, 0
    v_mov_b32_e64 v41, 0
    v_mov_b32_e64 v48, 0
    v_mov_b32_e64 v49, 0
    v_mov_b32_e64 v56, 0
    v_mov_b32_e64 v57, 0
    s_cmp_eq_u32 s25, 0
    s_cbranch_scc0 L_notrb
    ds_read_b64_tr_b16 v[224:225], v20 offset:0
    ds_read_b64_tr_b16 v[226:227], v20 offset:256
    ds_read_b64_tr_b16 v[228:229], v20 offset:4096
    ds_read_b64_tr_b16 v[230:231], v20 offset:4352
    ds_read_b64_tr_b16 v[240:241], v22 offset:0
    ds_read_b64_tr_b16 v[242:243], v22 offset:256
    ds_read_b64_tr_b16 v[244:245], v22 offset:4096
    ds_read_b64_tr_b16 v[246:247], v22 offset:4352
    ds_read_b64_tr_b16 v[232:233], v21 offset:0
    ds_read_b64_tr_b16 v[234:235], v21 offset:256
    ds_read_b64_tr_b16 v[236:237], v21 offset:4096
    ds_read_b64_tr_b16 v[238:239], v21 offset:4352
    ds_read_b64_tr_b16 v[248:249], v23 offset:0
    ds_read_b64_tr_b16 v[250:251], v23 offset:256
    ds_read_b64_tr_b16 v[252:253], v23 offset:4096
    ds_read_b64_tr_b16 v[254:255], v23 offset:4352
L_notrb:
    s_branch L_qjoin
.p2align 6
.fill 4, 4, 0xbf800000
L_att1:
    s_waitcnt lgkmcnt(0)
    s_barrier
    v_mov_b32 v192, 0
    v_mov_b32 v194, 0
    v_mov_b32 v196, 0
    v_mov_b32 v198, 0
    v_mov_b32 v200, 0
    v_mov_b32 v202, 0
    v_mov_b32 v204, 0
    v_mov_b32 v206, 0
    v_mov_b32 v208, 0
    v_mov_b32 v210, 0
    v_mov_b32 v212, 0
    v_mov_b32 v214, 0
    v_mov_b32 v216, 0
    v_mov_b32 v218, 0
    v_mov_b32 v220, 0
    v_mov_b32_e64 v222, 0
    s_cmp_eq_u32 s25, 0
    s_cbranch_scc0 L_notra
    ds_read_b64_tr_b16 v[224:225], v20 offset:0
    ds_read_b64_tr_b16 v[226:227], v20 offset:256
    ds_read_b64_tr_b16 v[228:229], v20 offset:4096
    ds_read_b64_tr_b16 v[230:231], v20 offset:4352
    ds_read_b64_tr_b16 v[240:241], v22 offset:0
    ds_read_b64_tr_b16 v[242:243], v22 offset:256
    ds_read_b64_tr_b16 v[244:245], v22 offset:4096
    ds_read_b64_tr_b16 v[246:247], v22 offset:4352
    ds_read_b64_tr_b16 v[232:233], v21 offset:0
    ds_read_b64_tr_b16 v[234:235], v21 offset:256
    ds_read_b64_tr_b16 v[236:237], v21 offset:4096
    ds_read_b64_tr_b16 v[238:239], v21 offset:4352
    ds_read_b64_tr_b16 v[248:249], v23 offset:0
    ds_read_b64_tr_b16 v[250:251], v23 offset:256
    ds_read_b64_tr_b16 v[252:253], v23 offset:4096
    ds_read_b64_tr_b16 v[254:255], v23 offset:4352
L_notra:
    s_barrier
    buffer_load_dwordx4 v[8:11], v30, s[68:71], s22 offen sc1
    v_mov_b32 v32, 0
    v_mov_b32 v33, 0
    v_mov_b32 v40, 0
    v_mov_b32 v41, 0
    v_mov_b32 v48, 0
    v_mov_b32 v49, 0
    v_mov_b32 v56, 0
    v_mov_b32 v57, 0
L_qjoin:
    buffer_load_dwordx4 v[8:11], v30, s[68:71], s22 offen sc1
    s_branch L_qpoll_chk
.p2align 6
L_qpoll:
    s_sub_u32 s12, s12, 1
    s_cbranch_scc1 L_end
    buffer_load_dwordx4 v[8:11], v30, s[68:71], s22 offen sc1
L_qpoll_chk:
    s_waitcnt vmcnt(1)
    v_max3_u32 v28, v8, v9, v10
    v_max_u32 v28, v28, v11
    v_cmp_eq_u32 vcc, -1, v28
    s_cbranch_vccnz L_qpoll
L_qpoll_ok:
    v_mov_b32_dpp v36, v8 quad_perm:[2,3,0,1] row_mask:0xf bank_mask:0xf
    v_smfmac_f32_16x16x64_bf16 v[32:35], v[8:11], v[64:71], v3
    v_mov_b32_dpp v37, v9 quad_perm:[2,3,0,1] row_mask:0xf bank_mask:0xf
    v_smfmac_f32_16x16x64_bf16 v[48:51], v[8:11], v[96:103], v3
    v_mov_b32_dpp v38, v10 quad_perm:[2,3,0,1] row_mask:0xf bank_mask:0xf
    v_smfmac_f32_16x16x64_bf16 v[40:43], v[8:11], v[80:87], v3
    v_mov_b32_dpp v39, v11 quad_perm:[2,3,0,1] row_mask:0xf bank_mask:0xf
    v_smfmac_f32_16x16x64_bf16 v[56:59], v[8:11], v[112:119], v3
    s_nop 0
    v_smfmac_f32_16x16x64_bf16 v[32:35], v[36:39], v[72:79], v3
    v_smfmac_f32_16x16x64_bf16 v[48:51], v[36:39], v[104:111], v3
    v_smfmac_f32_16x16x64_bf16 v[40:43], v[36:39], v[88:95], v3
    v_smfmac_f32_16x16x64_bf16 v[56:59], v[36:39], v[120:127], v3
    s_nop 4
    v_add_f32 v32, v32, v33
    v_add_f32 v48, v48, v49
    v_add_f32 v40, v40, v41
    s_nop 0
    v_permlane32_swap_b32 v32, v48
    v_add_f32 v56, v56, v57
    v_add_f32 v32, v32, v48
    s_nop 0
    v_permlane32_swap_b32 v40, v56
    v_add_f32 v40, v40, v56
    s_nop 1
    v_permlane16_swap_b32 v32, v40
    v_add_f32 v14, v32, v40
    s_nop 1
    v_max_f32_dpp v16, v14, v14 quad_perm:[1,0,3,2] row_mask:0xf bank_mask:0xf
    s_nop 1
    v_max_f32_dpp v16, v16, v16 quad_perm:[2,3,0,1] row_mask:0xf bank_mask:0xf
    s_nop 1
    v_max_f32_dpp v16, v16, v16 row_half_mirror row_mask:0xf bank_mask:0xf
    s_nop 1
    v_max_f32_dpp v16, v16, v16 row_mirror row_mask:0xf bank_mask:0xf
    s_nop 1
    v_max_f32_dpp v16, v16, v16 row_bcast:15 row_mask:0xa bank_mask:0xf
    s_nop 1
    v_max_f32_dpp v16, v16, v16 row_bcast:31 row_mask:0xc bank_mask:0xf
    s_nop 0
    v_readlane_b32 s21, v16, 63
    s_cmp_eq_u32 s9, 0
    s_nop 0
    v_subrev_f32 v14, s21, v14
    v_exp_f32 v14, v14
    s_nop 1
    v_mov_b32_dpp v15, v14 quad_perm:[1,1,3,3] row_mask:0xf bank_mask:0xf
    v_cvt_pk_bf16_f32 v20, v14, v15
    v_add_f32_dpp v17, v14, v14 quad_perm:[1,0,3,2] row_mask:0xf bank_mask:0xf
    s_nop 0
    v_mov_b32_dpp v21, v20 row_ror:12 row_mask:0xf bank_mask:0xf
    v_mov_b32_dpp v22, v20 row_ror:8 row_mask:0xf bank_mask:0xf
    v_mov_b32_dpp v23, v20 row_ror:4 row_mask:0xf bank_mask:0xf
    s_cbranch_scc1 L_vland
L_pv:
    s_cmp_lt_u32 s5, 4
    v_smfmac_f32_16x16x64_bf16 v[192:195], v[20:23], v[128:135], v3 abid:1
    v_add_f32_dpp v17, v17, v17 quad_perm:[2,3,0,1] row_mask:0xf bank_mask:0xf
    v_smfmac_f32_16x16x64_bf16 v[196:199], v[20:23], v[136:143], v3 abid:1
    s_nop 0
    v_add_f32_dpp v17, v17, v17 row_half_mirror row_mask:0xf bank_mask:0xf
    v_smfmac_f32_16x16x64_bf16 v[200:203], v[20:23], v[144:151], v3 abid:1
    s_nop 0
    v_add_f32_dpp v17, v17, v17 row_mirror row_mask:0xf bank_mask:0xf
    v_smfmac_f32_16x16x64_bf16 v[204:207], v[20:23], v[152:159], v3 abid:1
    s_nop 0
    v_add_f32_dpp v17, v17, v17 row_bcast:15 row_mask:0xa bank_mask:0xf
    v_smfmac_f32_16x16x64_bf16 v[208:211], v[20:23], v[160:167], v3 abid:1
    s_nop 0
    v_add_f32_dpp v17, v17, v17 row_bcast:31 row_mask:0xc bank_mask:0xf
    ds_write_b64 v6, v[16:17] offset:13824
    v_smfmac_f32_16x16x64_bf16 v[212:215], v[20:23], v[168:175], v3 abid:1
    v_add_f32 v32, v192, v194
    v_add_f32 v33, v196, v198
    v_smfmac_f32_16x16x64_bf16 v[216:219], v[20:23], v[176:183], v3 abid:1
    v_add_f32_e64 v34, v200, v202
    v_smfmac_f32_16x16x64_bf16 v[220:223], v[20:23], v[184:191], v3 abid:1
    v_add_f32_e64 v35, v204, v206
    s_cbranch_scc1 L_early
    s_waitcnt lgkmcnt(0)
    s_barrier
    s_mov_b64 exec, 0xffff
    ds_write_b128 v18, v[32:35] offset:9728
    v_add_f32 v36, v208, v210
    v_add_f32 v37, v212, v214
    v_add_f32 v38, v216, v218
    v_add_f32 v39, v220, v222
    ds_write_b128 v18, v[36:39] offset:9744
    s_mov_b64 exec, -1
L_noread:
    s_cmp_eq_u32 s9, 0
    s_waitcnt lgkmcnt(0)
    s_barrier
    s_cbranch_scc1 L_rank
    s_branch L_roles
.p2align 6
.fill 5, 4, 0xbf800000
L_awave:
    s_barrier
    v_mul_f32 v17, v16, v17
    s_cmp_eq_u32 s11, 0
    s_nop 0
    v_add_f32_dpp v17, v17, v17 quad_perm:[1,0,3,2] row_mask:0xf bank_mask:0xf
    s_nop 1
    v_add_f32_dpp v17, v17, v17 quad_perm:[2,3,0,1] row_mask:0xf bank_mask:0xf
    s_nop 1
    v_add_f32_dpp v17, v17, v17 row_half_mirror row_mask:0xf bank_mask:0xf
    v_log_f32_e64 v17, v17
    s_mov_b64 exec, 1
    v_add_f32_e64 v17, v17, v14
    v_min_u32_e64 v17, -2, v17
    s_cbranch_scc1 L_a_st_slow
    buffer_store_dword v17, off, s[68:71], s37
L_a_st_done:
    s_mov_b64 exec, -1
    s_branch L_roles
.p2align 6
.fill 4, 4, 0xbf800000
L_early:
    s_mov_b64 exec, 0xffff
    ds_write_b128 v18, v[32:35] offset:9728
    s_nop 1
    v_add_f32 v36, v208, v210
    v_add_f32 v37, v212, v214
    v_add_f32 v38, v216, v218
    v_add_f32 v39, v220, v222
    ds_write_b128 v18, v[36:39] offset:9744
    s_mov_b64 exec, -1
    s_cmp_eq_u32 s9, 0
    s_cbranch_scc1 L_pfw
L_pfw_done:
    s_cmp_lt_u32 s5, 2
    s_waitcnt lgkmcnt(0)
    s_barrier
    s_cbranch_scc0 L_noread
    ds_read_b64 v[16:17], v19 offset:13824
    ds_read2st64_b64 v[40:43], v12 offset0:19 offset1:20
    ds_read2st64_b64 v[44:47], v12 offset0:21 offset1:22
    s_cmp_eq_u32 s5, 1
    s_waitcnt lgkmcnt(2)
    v_max_f32_dpp v14, v16, v16 quad_perm:[1,0,3,2] row_mask:0xf bank_mask:0xf
    s_nop 1
    v_max_f32_dpp v14, v14, v14 quad_perm:[2,3,0,1] row_mask:0xf bank_mask:0xf
    s_nop 1
    v_max_f32_dpp v14, v14, v14 row_half_mirror row_mask:0xf bank_mask:0xf
    v_sub_f32 v16, v16, v14
    v_exp_f32 v16, v16
    s_waitcnt lgkmcnt(0)
    s_cbranch_scc1 L_awave
    v_mul_f32_dpp v20, v16, v40 row_newbcast:0 row_mask:0xf bank_mask:0xf
    v_mul_f32_dpp v21, v16, v41 row_newbcast:0 row_mask:0xf bank_mask:0xf
    v_mul_f32_dpp v22, v16, v42 row_newbcast:1 row_mask:0xf bank_mask:0xf
    v_mul_f32_dpp v23, v16, v43 row_newbcast:1 row_mask:0xf bank_mask:0xf
    v_fmac_f32_dpp v20, v16, v44 row_newbcast:2 row_mask:0xf bank_mask:0xf
    v_fmac_f32_dpp v21, v16, v45 row_newbcast:2 row_mask:0xf bank_mask:0xf
    v_fmac_f32_dpp v22, v16, v46 row_newbcast:3 row_mask:0xf bank_mask:0xf
    v_fmac_f32_dpp v23, v16, v47 row_newbcast:3 row_mask:0xf bank_mask:0xf
    s_barrier
    ds_read2st64_b64 v[48:51], v12 offset0:23 offset1:24
    ds_read2st64_b64 v[52:55], v12 offset0:25 offset1:26
    v_mul_f32 v17, v16, v17
    s_cmp_eq_u32 s11, 0
    s_nop 0
    v_add_f32_dpp v17, v17, v17 quad_perm:[1,0,3,2] row_mask:0xf bank_mask:0xf
    s_nop 0
    s_nop 0
    v_add_f32_dpp v17, v17, v17 quad_perm:[2,3,0,1] row_mask:0xf bank_mask:0xf
    s_nop 0
    s_nop 0
    v_add_f32_dpp v17, v17, v17 row_half_mirror row_mask:0xf bank_mask:0xf
    v_rcp_f32_e64 v15, v17
    s_waitcnt lgkmcnt(1)
    v_fmac_f32_dpp v20, v16, v48 row_newbcast:4 row_mask:0xf bank_mask:0xf
    v_fmac_f32_dpp v21, v16, v49 row_newbcast:4 row_mask:0xf bank_mask:0xf
    v_fmac_f32_dpp v22, v16, v50 row_newbcast:5 row_mask:0xf bank_mask:0xf
    v_fmac_f32_dpp v23, v16, v51 row_newbcast:5 row_mask:0xf bank_mask:0xf
    s_waitcnt lgkmcnt(0)
    v_fmac_f32_dpp v20, v16, v52 row_newbcast:6 row_mask:0xf bank_mask:0xf
    v_fmac_f32_dpp v21, v16, v53 row_newbcast:6 row_mask:0xf bank_mask:0xf
    v_fmac_f32_dpp v22, v16, v54 row_newbcast:7 row_mask:0xf bank_mask:0xf
    v_fmac_f32_dpp v23, v16, v55 row_newbcast:7 row_mask:0xf bank_mask:0xf
    v_pk_add_f32 v[20:21], v[20:21], v[22:23]
    v_pk_mul_f32 v[20:21], v[20:21], v[14:15] op_sel:[0,1] op_sel_hi:[1,1]
    v_cvt_pk_bf16_f32 v20, v20, v21
    v_min_u32_e64 v20, -2, v20
    s_cbranch_scc1 L_o_st_slow
    buffer_store_dword v20, v24, s[68:71], s36 offen
L_o_st_done:
    s_cmp_eq_u32 s9, 0
    s_cbranch_scc1 L_pf2
L_roles:
    s_cmp_eq_u32 s25, 0
    s_cbranch_scc0 L_notwo
    s_cmp_eq_u32 s9, 0
    s_cbranch_scc1 L_wo_dma
L_wo_have:
    buffer_load_dword v14, v27, s[68:71], s39 offen sc1
    v_mov_b32 v192, 0
    v_mov_b32 v193, 0
    v_mov_b32 v194, 0
    v_mov_b32 v195, 0
    v_mov_b32 v196, 0
    v_mov_b32 v197, 0
    v_mov_b32 v198, 0
    v_mov_b32 v199, 0
    v_mov_b32 v200, 0
    v_mov_b32 v201, 0
    v_mov_b32 v202, 0
    v_mov_b32 v203, 0
    v_mov_b32 v204, 0
    v_mov_b32 v205, 0
    v_mov_b32 v206, 0
    v_mov_b32 v207, 0
    buffer_load_dword v14, v27, s[68:71], s39 offen sc1
    s_branch L_apoll_chk
.p2align 6
.fill 7, 4, 0xbf800000
L_apoll:
    s_sub_u32 s12, s12, 1
    s_cbranch_scc1 L_end
    buffer_load_dword v14, v27, s[68:71], s39 offen sc1
L_apoll_chk:
    s_waitcnt vmcnt(1)
    v_cmp_eq_u32 vcc, -1, v14
    s_cbranch_vccnz L_apoll
L_apoll_ok:
    buffer_load_dwordx4 v[8:11], v30, s[68:71], s38 offen sc1
    v_max_f32_dpp v16, v14, v14 quad_perm:[1,0,3,2] row_mask:0xf bank_mask:0xf
    s_nop 1
    v_max_f32_dpp v16, v16, v16 quad_perm:[2,3,0,1] row_mask:0xf bank_mask:0xf
    s_nop 1
    v_max_f32_dpp v16, v16, v16 row_half_mirror row_mask:0xf bank_mask:0xf
    v_sub_f32 v15, v14, v16
    v_exp_f32 v15, v15
    s_nop 1
    v_add_f32_dpp v16, v15, v15 quad_perm:[1,0,3,2] row_mask:0xf bank_mask:0xf
    s_nop 1
    v_add_f32_dpp v16, v16, v16 quad_perm:[2,3,0,1] row_mask:0xf bank_mask:0xf
    s_nop 1
    v_add_f32_dpp v16, v16, v16 row_half_mirror row_mask:0xf bank_mask:0xf
    v_rcp_f32 v16, v16
    s_waitcnt lgkmcnt(0)
    v_mul_f32 v15, v15, v16
    s_nop 1
    v_mov_b32_dpp v16, v15 row_newbcast:0 row_mask:0xf bank_mask:0xf
    v_mov_b32_dpp v17, v15 row_newbcast:1 row_mask:0xf bank_mask:0xf
    s_branch L_opoll_chk
.p2align 6
.fill 1, 4, 0xbf800000
L_opoll:
    s_sub_u32 s12, s12, 1
    s_cbranch_scc1 L_end
    buffer_load_dwordx4 v[8:11], v30, s[68:71], s38 offen sc1
    s_nop 1
L_opoll_z:
    v_mov_b32 v192, 0
    v_mov_b32 v193, 0
    v_mov_b32 v194, 0
    v_mov_b32 v195, 0
    v_mov_b32 v200, 0
    v_mov_b32 v201, 0
    v_mov_b32 v202, 0
    v_mov_b32 v203, 0
    v_mov_b32 v196, 0
    v_mov_b32 v197, 0
    v_mov_b32 v198, 0
    v_mov_b32 v199, 0
    v_mov_b32 v204, 0
    v_mov_b32 v205, 0
    v_mov_b32 v206, 0
    v_mov_b32 v207, 0
L_opoll_chk:
    s_waitcnt vmcnt(0)
    v_smfmac_f32_16x16x64_bf16 v[192:195], v[8:11], v[224:231], v3
    v_max3_u32 v28, v8, v9, v10
    v_smfmac_f32_16x16x64_bf16 v[200:203], v[8:11], v[240:247], v3
    v_max_u32 v28, v28, v11
    v_smfmac_f32_16x16x64_bf16 v[196:199], v[8:11], v[232:239], v3
    v_cmp_eq_u32 vcc, -1, v28
    v_smfmac_f32_16x16x64_bf16 v[204:207], v[8:11], v[248:255], v3
    s_cbranch_vccnz L_opoll
    s_nop 0
    v_add_f32 v192, v192, v193
    v_add_f32 v194, v194, v195
    v_mul_f32 v192, v16, v192
    v_fmac_f32 v192, v17, v194
    v_add_f32 v200, v200, v201
    v_add_f32 v202, v202, v203
    v_mul_f32 v200, v16, v200
    v_fmac_f32 v200, v17, v202
    v_add_f32 v196, v196, v197
    v_add_f32 v198, v198, v199
    v_mul_f32 v196, v16, v196
    v_fmac_f32 v196, v17, v198
    v_permlane32_swap_b32 v192, v200
    v_add_f32 v204, v204, v205
    v_add_f32 v206, v206, v207
    v_mul_f32_e64 v204, v16, v204
    v_fmac_f32_e64 v204, v17, v206
    v_add_f32_e64 v192, v192, v200
    s_nop 0
    v_permlane32_swap_b32 v196, v204
    v_add_f32_e64 v196, v196, v204
    s_nop 0
    s_nop 0
    v_permlane16_swap_b32 v192, v196
    v_add_f32_e64 v192, v192, v196
    ds_write_b32 v5, v192 offset:0
    s_cmp_eq_u32 s5, 0
    s_waitcnt lgkmcnt(0)
    s_barrier
    s_cbranch_scc0 L_wo_done
    ds_read2st64_b32 v[40:41], v5 offset0:0 offset1:1
    ds_read2st64_b32 v[42:43], v5 offset0:2 offset1:3
    ds_read2st64_b32 v[44:45], v5 offset0:4 offset1:5
    ds_read2st64_b32 v[46:47], v5 offset0:6 offset1:7
    s_waitcnt lgkmcnt(2)
    v_pk_add_f32 v[40:41], v[40:41], v[42:43]
    s_xor_b32 s16, s40, 8192
    s_waitcnt lgkmcnt(0)
    v_pk_add_f32 v[44:45], v[44:45], v[46:47]
    v_pk_add_f32 v[40:41], v[40:41], v[44:45]
    v_add_f32 v40, v40, v41
    s_nop 1
    v_mov_b32_dpp v41, v40 quad_perm:[1,1,3,3] row_mask:0xf bank_mask:0xf
    v_cvt_pk_bf16_f32 v42, v40, v41
    v_min_u32 v42, -2, v42
    buffer_store_dword v42, v13, s[68:71], s40 offen sc1
    buffer_store_dword v42, v13, s[68:71], s16 offen sc1
    s_lshl_b32 s13, s41, 2
    s_add_u32 s13, s13, s86
    v_lshlrev_b32 v28, 7, v0
    s_mov_b64 exec, 15
    s_cmp_eq_u32 s11, 0
    s_cbranch_scc1 L_yf_slow
    buffer_store_dword v0, v28, s[68:71], s13 offen
L_yf_done:
    s_mov_b64 exec, -1
    s_cmp_eq_u32 s9, 0
    s_cbranch_scc1 L_w2_bar
L_wo_done:
    s_cmp_eq_u32 s9, 0
    s_cbranch_scc0 L_w2_have
    v_lshrrev_b32 v20, 3, v0
    v_mul_u32_u24 v20, 1280, v20
    v_and_b32 v28, 0x70, v30
    v_and_b32 v29, 32, v0
    v_xor_b32 v28, v28, v29
    v_add_u32 v20, v20, v28
    v_xor_b32 v21, 64, v20
    s_mul_i32 s13, s3, 224
    s_lshl_b32 s14, s5, 5
    s_add_u32 s13, s13, s14
    s_sub_u32 s13, s13, 32
    s_mul_i32 s13, s13, 1280
    s_lshl_b32 s14, s41, 7
    s_add_u32 s13, s13, s14
    s_lshl_b32 s16, s5, 12
    s_cmp_eq_u32 s5, 0
L_w2_bar:
    s_barrier
    s_cbranch_scc1 L_w2_iss
    s_add_u32 m0, s16, 99328
    s_nop 0
    buffer_load_dwordx4 v20, s[80:83], s13 offen nt lds
    s_add_u32 m0, s16, 100352
    s_add_u32 s13, s13, 10240
    buffer_load_dwordx4 v21, s[80:83], s13 offen nt lds
    s_add_u32 m0, s16, 101376
    s_add_u32 s13, s13, 10240
    buffer_load_dwordx4 v20, s[80:83], s13 offen nt lds
    s_add_u32 m0, s16, 102400
    s_add_u32 s13, s13, 10240
    buffer_load_dwordx4 v21, s[80:83], s13 offen nt lds
    s_sub_u32 s20, s5, 5
    s_cmp_lt_u32 s20, 2
    s_cbranch_scc1 L_down
    s_waitcnt vmcnt(0)
L_w2_iss:
    s_barrier
L_w2_have:
    s_sub_u32 s20, s5, 5
    s_cmp_lt_u32 s20, 2
    s_cbranch_scc0 L_nextlayer
L_down:
    v_lshlrev_b32 v21, 7, v1
    v_and_b32 v28, 12, v1
    v_lshl_add_u32 v21, v28, 3, v21
    v_and_b32 v28, 3, v0
    v_lshl_add_u32 v21, v28, 3, v21
    s_lshl_b32 s13, s20, 6
    v_xor_b32 v21, s13, v21
    v_add_u32 v21, 103424, v21
    v_and_b32 v20, 32, v0
    v_lshl_add_u32 v20, v20, 7, v21
    v_xor_b32 v22, 32, v20
    v_xor_b32 v23, 32, v21
    v_mov_b32 v32, 0
    v_mov_b32 v33, 0
    v_mov_b32 v34, 0
    v_mov_b32 v35, 0
    v_mov_b32 v36, 0
    v_mov_b32 v37, 0
    v_mov_b32 v38, 0
    v_mov_b32 v39, 0
    v_mov_b32 v40, 0
    v_mov_b32 v41, 0
    v_mov_b32 v42, 0
    v_mov_b32 v43, 0
    v_mov_b32 v44, 0
    v_mov_b32 v45, 0
    v_mov_b32 v46, 0
    v_mov_b32 v47, 0
    v_mov_b32 v26, 2130706432
    v_cmp_gt_u32 vcc, s47, v2
    s_lshl_b32 s22, s3, 9
    s_add_u32 s22, s22, s10
    v_cndmask_b32 v25, v26, v2, vcc
    s_add_u32 s22, s22, 141312
    v_cmp_gt_u32 vcc, 32, v0
    s_and_b32 s15, s3, 1
    s_mul_i32 s15, s15, 1280
    v_cndmask_b32_e64 v26, v26, v13, vcc
    s_add_u32 s13, s41, s20
    s_lshl_b32 s13, s13, 7
    s_add_u32 s15, s15, s13
    s_add_u32 s15, s15, s40
    s_add_u32 s15, s15, 2560
    s_xor_b32 s16, s15, 8192
    s_setprio 3
    s_cmp_eq_u32 s9, 0
    s_cbranch_scc0 L_dn_1
    s_waitcnt vmcnt(0)
    s_barrier
    s_branch L_dn_rd
L_dn_1:
L_dn_rd:
    buffer_load_dwordx4 v[8:11], v2, s[68:71], s22 offen sc1
    buffer_load_dwordx4 v[48:51], v25, s[68:71], s22 offen offset:256 sc1
    ds_read_b64_tr_b16 v[192:193], v20 offset:0
    ds_read_b64_tr_b16 v[194:195], v20 offset:256
    ds_read_b64_tr_b16 v[196:197], v20 offset:8192
    ds_read_b64_tr_b16 v[198:199], v20 offset:8448
    ds_read_b64_tr_b16 v[200:201], v20 offset:2048
    ds_read_b64_tr_b16 v[202:203], v20 offset:2304
    ds_read_b64_tr_b16 v[204:205], v20 offset:10240
    ds_read_b64_tr_b16 v[206:207], v20 offset:10496
    ds_read_b64_tr_b16 v[208:209], v20 offset:16384
    ds_read_b64_tr_b16 v[210:211], v20 offset:16640
    ds_read_b64_tr_b16 v[212:213], v21 offset:24576
    ds_read_b64_tr_b16 v[214:215], v21 offset:24832
    ds_read_b64_tr_b16 v[216:217], v20 offset:18432
    ds_read_b64_tr_b16 v[218:219], v20 offset:18688
    ds_read_b64_tr_b16 v[220:221], v21 offset:26624
    ds_read_b64_tr_b16 v[222:223], v21 offset:26880
    ds_read_b64_tr_b16 v[224:225], v22 offset:0
    ds_read_b64_tr_b16 v[226:227], v22 offset:256
    ds_read_b64_tr_b16 v[228:229], v22 offset:8192
    ds_read_b64_tr_b16 v[230:231], v22 offset:8448
    ds_read_b64_tr_b16 v[232:233], v22 offset:2048
    ds_read_b64_tr_b16 v[234:235], v22 offset:2304
    ds_read_b64_tr_b16 v[236:237], v22 offset:10240
    ds_read_b64_tr_b16 v[238:239], v22 offset:10496
    ds_read_b64_tr_b16 v[240:241], v22 offset:16384
    ds_read_b64_tr_b16 v[242:243], v22 offset:16640
    ds_read_b64_tr_b16 v[244:245], v23 offset:24576
    ds_read_b64_tr_b16 v[246:247], v23 offset:24832
    ds_read_b64_tr_b16 v[248:249], v22 offset:18432
    ds_read_b64_tr_b16 v[250:251], v22 offset:18688
    ds_read_b64_tr_b16 v[252:253], v23 offset:26624
    ds_read_b64_tr_b16 v[254:255], v23 offset:26880
    s_waitcnt lgkmcnt(0)
    buffer_load_dwordx4 v[8:11], v2, s[68:71], s22 offen sc1
    buffer_load_dwordx4 v[48:51], v25, s[68:71], s22 offen offset:256 sc1
    s_branch L_hpoll_chk
.p2align 6
L_hpoll:
    s_sub_u32 s12, s12, 1
    s_cbranch_scc1 L_end
    buffer_load_dwordx4 v[8:11], v2, s[68:71], s22 offen sc1
    buffer_load_dwordx4 v[48:51], v25, s[68:71], s22 offen offset:256 sc1
    s_nop 2
    v_mov_b32 v32, 0
    v_mov_b32 v33, 0
L_hpoll_chk:
    s_waitcnt vmcnt(2)
    v_max3_u32 v28, v8, v9, v10
    v_max3_u32 v29, v11, v48, v49
    v_max3_u32 v28, v28, v51, v50
    v_max_u32_e64 v28, v28, v29
    v_cmp_eq_u32_e64 vcc, -1, v28
    v_smfmac_f32_16x16x64_bf16 v[32:35], v[8:11], v[192:199], v3
    v_smfmac_f32_16x16x64_bf16 v[32:35], v[48:51], v[208:215], v3
    s_cbranch_vccnz L_hpoll
L_hpoll_go:
    v_smfmac_f32_16x16x64_bf16 v[36:39], v[8:11], v[200:207], v3
    v_smfmac_f32_16x16x64_bf16 v[36:39], v[48:51], v[216:223], v3
    v_smfmac_f32_16x16x64_bf16 v[40:43], v[8:11], v[224:231], v3
    v_smfmac_f32_16x16x64_bf16 v[40:43], v[48:51], v[240:247], v3
    v_smfmac_f32_16x16x64_bf16 v[44:47], v[8:11], v[232:239], v3
    v_smfmac_f32_16x16x64_bf16 v[44:47], v[48:51], v[248:255], v3
    s_nop 0
    v_add_f32 v32, v32, v33
    s_nop 1
    v_add_f32 v38, v38, v39
    v_add_f32 v14, v32, v38
    v_add_f32 v40, v40, v41
    s_nop 0
    v_add_f32 v46, v46, v47
    s_nop 1
    v_add_f32_dpp v14, v40, v46 quad_perm:[0,1,2,3] row_mask:0x2 bank_mask:0xf
    s_nop 1
    v_mov_b32_dpp v15, v14 quad_perm:[1,1,3,3] row_mask:0xf bank_mask:0xf
    v_cvt_pk_bf16_f32 v22, v14, v15
    v_min_u32 v22, -2, v22
    buffer_store_dword v22, v26, s[68:71], s15 offen sc1
    buffer_store_dword v22, v26, s[68:71], s16 offen sc1
    s_waitcnt vmcnt(2)
    s_branch L_nextlayer
L_notwo:
    s_cmp_eq_u32 s25, 2
    s_cbranch_scc1 L_nextlayer
    s_cmp_eq_u32 s9, 0
    s_cbranch_scc0 L_w13_have
    s_mul_i32 s13, s3, 448
    s_lshl_b32 s14, s41, 5
    s_add_u32 s13, s13, s14
    s_sub_u32 s13, s13, 320
    s_mul_i32 s14, s5, 55296
    s_add_u32 s13, s13, s14
    v_lshrrev_b32 v21, 2, v0
    v_lshrrev_b32 v20, 4, v0
    v_and_b32 v20, 2, v20
    v_xor_b32 v21, v21, v20
    v_mul_u32_u24 v21, 3456, v21
    v_xor_b32 v20, v30, v0
    v_and_b32 v20, 16, v20
    v_add3_u32 v21, s13, v21, v20
    v_and_b32 v20, 2, v0
    v_cmp_eq_u32 vcc, 0, v20
    v_mov_b32 v22, s50
    v_mov_b32 v23, s51
    v_mov_b32 v14, s48
    v_mov_b32 v15, s49
    v_cndmask_b32 v22, v22, v14, vcc
    v_cndmask_b32 v23, v23, v15, vcc
    v_add_co_u32 v22, vcc, v22, v21
    s_nop 1
    v_addc_co_u32 v23, vcc, 0, v23, vcc
    s_lshl_b32 s15, s5, 10
    s_barrier
    s_add_u32 m0, s15, 37888
    s_nop 0
    global_load_lds_dwordx4 v[22:23], off
    v_add_co_u32 v22, vcc, 442368, v22
    s_nop 1
    v_addc_co_u32 v23, vcc, 0, v23, vcc
    s_add_u32 m0, s15, 46080
    s_nop 0
    global_load_lds_dwordx4 v[22:23], off
    v_add_co_u32 v22, vcc, 442368, v22
    s_nop 1
    v_addc_co_u32 v23, vcc, 0, v23, vcc
    s_add_u32 m0, s15, 54272
    s_nop 0
    global_load_lds_dwordx4 v[22:23], off
    v_add_co_u32 v22, vcc, 442368, v22
    s_nop 1
    v_addc_co_u32 v23, vcc, 0, v23, vcc
    s_add_u32 m0, s15, 62464
    s_nop 0
    global_load_lds_dwordx4 v[22:23], off
    v_add_co_u32 v22, vcc, 442368, v22
    s_nop 1
    v_addc_co_u32 v23, vcc, 0, v23, vcc
    s_add_u32 m0, s15, 70656
    s_nop 0
    global_load_lds_dwordx4 v[22:23], off
    s_branch L_w13_iss
L_w13_have:
    s_barrier
L_w13_iss:
    s_mov_b32 s46, 1
    s_cmp_ge_u32 s5, 4
    s_cbranch_scc0 L_up_g
    s_sub_u32 s20, s5, 4
    v_and_b32 v14, 32, v0
    v_and_b32 v15, 2, v0
    v_lshl_add_u32 v14, v15, 3, v14
    v_add_u32 v14, v14, v1
    v_lshlrev_b32 v14, 6, v14
    v_and_b32 v15, 1, v0
    v_lshl_add_u32 v14, v15, 5, v14
    v_and_b32 v15, 8, v0
    v_lshl_add_u32 v14, v15, 4, v14
    v_and_b32 v15, 16, v0
    v_add_u32 v14, v14, v15
    s_lshl_b32 s13, s20, 3
    v_xor_b32 v14, s13, v14
    v_add_u32 v14, 37888, v14
    v_xor_b32 v17, 128, v14
    v_mov_b32 v252, 0
    v_mov_b32 v253, 0
    v_mov_b32_e64 v254, 0
    v_mov_b32_e64 v255, 0
    v_and_b32_e64 v15, 12, v0
    v_cmp_eq_u32_e64 vcc, 4, v15
    v_mov_b32 v15, 12288
    s_lshl_b32 s23, s3, 9
    v_cndmask_b32_e64 v16, v2, v15, vcc
    v_cmp_gt_u32_e64 vcc, 4, v0
    v_mov_b32 v15, 2130706432
    s_add_u32 s23, s23, s13
    v_cndmask_b32_e64 v25, v15, v13, vcc
    s_lshl_b32 s13, s41, 5
    s_add_u32 s23, s23, s13
    s_add_u32 s23, s23, 140992
    s_add_u32 s23, s23, s10
    s_setprio 3
    s_cmp_eq_u32 s9, 0
    s_cbranch_scc1 L_up0
    ds_read_b64_tr_b16 v[192:193], v14 offset:0
    ds_read_b64_tr_b16 v[194:195], v17 offset:0
    ds_read_b64_tr_b16 v[196:197], v14 offset:4096
    ds_read_b64_tr_b16 v[198:199], v17 offset:4096
    ds_read_b64_tr_b16 v[200:201], v14 offset:8192
    ds_read_b64_tr_b16 v[202:203], v17 offset:8192
    ds_read_b64_tr_b16 v[204:205], v14 offset:12288
    ds_read_b64_tr_b16 v[206:207], v17 offset:12288
    ds_read_b64_tr_b16 v[208:209], v14 offset:16384
    ds_read_b64_tr_b16 v[210:211], v17 offset:16384
    ds_read_b64_tr_b16 v[212:213], v14 offset:20480
    ds_read_b64_tr_b16 v[214:215], v17 offset:20480
    ds_read_b64_tr_b16 v[216:217], v14 offset:24576
    ds_read_b64_tr_b16 v[218:219], v17 offset:24576
    ds_read_b64_tr_b16 v[220:221], v14 offset:28672
    ds_read_b64_tr_b16 v[222:223], v17 offset:28672
    ds_read_b64_tr_b16 v[224:225], v14 offset:32768
    ds_read_b64_tr_b16 v[226:227], v17 offset:32768
    ds_read_b64_tr_b16 v[228:229], v14 offset:36864
    ds_read_b64_tr_b16 v[230:231], v17 offset:36864
    s_cmp_eq_u32 s5, 4
    s_cbranch_scc0 L_up_bar
    s_branch L_g
L_up_g:
    s_branch L_g
.p2align 6
.fill 6, 4, 0xbf800000
L_up_m:
    s_cmp_ge_u32 s5, 4
    s_cbranch_scc0 L_up_nom
L_up_bar:
    s_waitcnt lgkmcnt(0)
    s_barrier
    ds_read_b64 v[32:33], v12 offset:7168
    ds_read_b64 v[34:35], v12 offset:7680
    ds_read_b64 v[36:37], v12 offset:8192
    ds_read_b64 v[38:39], v12 offset:8704
    ds_read_b64 v[40:41], v12 offset:9216
    ds_read_b128 v[232:235], v16 offset:3328
    ds_read_b128 v[236:239], v16 offset:3584
    ds_read_b128 v[240:243], v16 offset:3840
    ds_read_b128 v[244:247], v16 offset:4096
    ds_read_b128 v[248:251], v16 offset:4352
    v_mov_b32 v42, 1e-05
    s_cmp_eq_u32 s11, 0
    s_waitcnt lgkmcnt(6)
    v_pk_add_f32 v[32:33], v[32:33], v[34:35]
    v_pk_add_f32 v[36:37], v[36:37], v[38:39]
    s_waitcnt lgkmcnt(5)
    v_pk_add_f32 v[32:33], v[32:33], v[40:41]
    v_pk_add_f32 v[32:33], v[32:33], v[36:37]
    s_waitcnt lgkmcnt(4)
    v_smfmac_f32_16x16x64_bf16 v[252:255], v[232:235], v[192:199], v3
    v_add_f32_dpp v32, v32, v32 quad_perm:[1,0,3,2] row_mask:0xf bank_mask:0xf
    v_add_f32_dpp v33, v33, v33 quad_perm:[1,0,3,2] row_mask:0xf bank_mask:0xf
    s_waitcnt lgkmcnt(3)
    v_smfmac_f32_16x16x64_bf16 v[252:255], v[236:239], v[200:207], v3
    v_add_f32_dpp v32, v32, v32 quad_perm:[2,3,0,1] row_mask:0xf bank_mask:0xf
    v_add_f32_dpp v33, v33, v33 quad_perm:[2,3,0,1] row_mask:0xf bank_mask:0xf
    s_waitcnt lgkmcnt(2)
    v_smfmac_f32_16x16x64_bf16 v[252:255], v[240:243], v[208:215], v3
    v_add_f32_dpp v32, v32, v32 row_half_mirror row_mask:0xf bank_mask:0xf
    v_add_f32_dpp v33, v33, v33 row_half_mirror row_mask:0xf bank_mask:0xf
    s_waitcnt lgkmcnt(1)
    v_smfmac_f32_16x16x64_bf16 v[252:255], v[244:247], v[216:223], v3
    v_add_f32_dpp v32, v32, v32 row_mirror row_mask:0xf bank_mask:0xf
    v_add_f32_dpp v33, v33, v33 row_mirror row_mask:0xf bank_mask:0xf
    s_waitcnt lgkmcnt(0)
    v_smfmac_f32_16x16x64_bf16 v[252:255], v[248:251], v[224:231], v3
    v_add_f32_dpp v32, v32, v32 row_bcast:15 row_mask:0xa bank_mask:0xf
    v_add_f32_dpp v33, v33, v33 row_bcast:15 row_mask:0xa bank_mask:0xf
    s_nop 0
    v_add_f32_dpp v32, v32, v32 row_bcast:31 row_mask:0xc bank_mask:0xf
    v_add_f32_dpp v33, v33, v33 row_bcast:31 row_mask:0xc bank_mask:0xf
    v_mul_f32 v32, 0.0015625, v32
    v_fmamk_f32 v33, v33, 0.0015625, v42
    v_fma_f32 v33, -v32, v32, v33
    v_max_f32 v33, v42, v33
    v_add_f32 v254, v254, v255
    v_rsq_f32 v33, v33
    v_add_f32 v252, v252, v253
    v_readlane_b32 s13, v32, 63
    s_nop 0
    v_add_f32_dpp v43, v254, v252 row_shl:8 row_mask:0xf bank_mask:0xf
    v_add_f32_dpp v252, v254, v252 row_shl:8 row_mask:0xf bank_mask:0xf
    v_readlane_b32 s14, v33, 63
    s_nop 0
    v_permlane16_swap_b32 v252, v43
    v_fma_f32 v252, -s13, v43, v252
    v_mul_f32 v252, s14, v252
    v_mul_f32 v34, -1.4426950408889634, v252
    v_exp_f32 v34, v34
    v_mul_f32_dpp v252, v252, v252 row_shl:4 row_mask:0xf bank_mask:0xf
    v_add_f32 v34, 1.0, v34
    v_rcp_f32 v34, v34
    s_nop 0
    v_mul_f32 v252, v252, v34
    s_nop 1
    v_mov_b32_dpp v34, v252 quad_perm:[1,1,3,3] row_mask:0xf bank_mask:0xf
    v_cvt_pk_bf16_f32 v35, v252, v34
    v_min_u32 v35, -2, v35
    s_cbranch_scc1 L_h_st_slow
    buffer_store_dword v35, v25, s[68:71], s23 offen
L_h_st_done:
L_xpub:
    s_cmp_eq_u32 s41, 10
    s_cselect_b32 s13, s5, 7
    s_cmp_lt_u32 s13, 5
    s_cbranch_scc0 L_nextlayer
    s_add_u32 s13, s47, 256
    v_cmp_gt_u32 vcc, s13, v12
    v_mov_b32 v23, 2130706432
    s_lshl_b32 s22, s3, 9
    s_add_u32 s22, s22, s10
    v_cndmask_b32 v20, v23, v12, vcc
    s_add_u32 s22, s22, 141312
    buffer_load_dwordx2 v[14:15], v20, s[68:71], s22 offen sc1
    s_branch L_tpoll_chk
.p2align 6
.fill 6, 4, 0xbf800000
L_tpoll:
    s_sub_u32 s12, s12, 1
    s_cbranch_scc1 L_end
    buffer_load_dwordx2 v[14:15], v20, s[68:71], s22 offen sc1
L_tpoll_chk:
    s_waitcnt vmcnt(0)
    v_max_u32 v28, v14, v15
    v_cmp_eq_u32 vcc, -1, v28
    s_cbranch_vccnz L_tpoll
L_tpoll_ok:
    v_min_u32 v45, -2, v4
    s_cmp_eq_u32 s11, 0
    s_cbranch_scc1 L_x_st_slow
    buffer_store_dword v45, v5, s[68:71], s21 offen
L_x_st_done:
L_nextlayer:
    s_setprio 0
    s_add_u32 s9, s9, 1
    s_add_u32 s10, s10, 147456
    s_add_u32 s86, s86, 147456
    s_mov_b32 s46, 0
    s_cmp_eq_u32 s9, 2
    s_cbranch_scc1 L_last
    s_add_u32 s36, s36, 147456
    s_add_u32 s37, s37, 147456
    s_add_u32 s38, s38, 147456
    s_add_u32 s39, s39, 147456
    s_add_u32 s40, s40, 147456
    s_lshl_b32 s22, s6, 10
    s_add_u32 s22, s22, 327680
    v_lshlrev_b32 v20, 7, v1
    v_and_b32 v28, 12, v1
    v_lshl_add_u32 v20, v28, 3, v20
    v_and_b32 v28, 3, v0
    v_lshl_add_u32 v20, v28, 3, v20
    v_and_b32 v28, 32, v0
    v_lshl_add_u32 v20, v28, 6, v20
    s_lshl_b32 s13, s5, 13
    s_add_u32 s13, s13, 37888
    v_add_u32 v20, s13, v20
    v_xor_b32 v21, 32, v20
    v_xor_b32 v22, 64, v20
    v_xor_b32 v23, 96, v20
    s_cmp_eq_u32 s5, 7
    s_cbranch_scc0 L_nowarm
    s_lshl_b32 s13, s3, 13
    s_add_u32 s13, s13, s10
    s_lshl_b32 s15, s3, 7
    s_add_u32 s15, s15, s10
    s_add_u32 s15, s15, 145408
    s_cmp_lt_u32 s41, 2
    s_cselect_b32 s16, s5, 99
    s_cmp_eq_u32 s16, 7
    s_cselect_b32 s13, s13, 2130706432
    s_cselect_b32 s15, s15, 2130706432
    v_lshlrev_b32 v28, 7, v0
    buffer_load_dword v31, v28, s[68:71], s13 offen sc1
    buffer_load_dword v31, off, s[68:71], s15 sc1
    s_lshl_b32 s13, s6, 10
    s_add_u32 s13, s13, 327680
    buffer_load_dword v31, v30, s[68:71], s13 offen sc1
L_nowarm:
    s_cmp_ge_u32 s5, 4
    s_cbranch_scc0 L_g
    v_mov_b32 v192, 0
    v_mov_b32 v194, 0
    v_mov_b32 v196, 0
    v_mov_b32 v198, 0
    v_mov_b32 v200, 0
    v_mov_b32 v202, 0
    v_mov_b32 v204, 0
    v_mov_b32 v206, 0
    v_mov_b32 v208, 0
    v_mov_b32 v210, 0
    v_mov_b32 v212, 0
    v_mov_b32 v214, 0
    v_mov_b32 v216, 0
    v_mov_b32 v218, 0
    v_mov_b32 v220, 0
    v_mov_b32 v222, 0
    s_sub_u32 s20, s5, 4
    v_lshlrev_b32 v14, 7, v1
    v_and_b32 v28, 12, v1
    v_lshl_add_u32 v14, v28, 3, v14
    v_and_b32 v28, 3, v0
    v_lshl_add_u32 v14, v28, 3, v14
    v_and_b32 v28, 32, v0
    v_lshl_add_u32 v14, v28, 6, v14
    s_lshl_b32 s13, s20, 5
    v_xor_b32 v14, s13, v14
    ds_read_b64_tr_b16 v[224:225], v14 offset:17408
    ds_read_b64_tr_b16 v[226:227], v14 offset:17664
    ds_read_b64_tr_b16 v[228:229], v14 offset:21504
    ds_read_b64_tr_b16 v[230:231], v14 offset:21760
    ds_read_b64_tr_b16 v[232:233], v14 offset:25600
    ds_read_b64_tr_b16 v[234:235], v14 offset:25856
    ds_read_b64_tr_b16 v[236:237], v14 offset:29696
    ds_read_b64_tr_b16 v[238:239], v14 offset:29952
    ds_read_b64_tr_b16 v[240:241], v14 offset:33792
    ds_read_b64_tr_b16 v[242:243], v14 offset:34048
    v_mov_b32 v244, 0
    v_mov_b32 v248, 0
    v_mov_b32 v245, 0
    v_mov_b32 v249, 0
    v_mov_b32 v246, 0
    v_mov_b32 v250, 0
    v_mov_b32 v247, 0
    v_mov_b32 v251, 0
    v_and_b32 v16, 48, v0
    v_and_b32 v15, 1, v0
    v_lshlrev_b32 v16, 1, v16
    v_lshl_add_u32 v16, v15, 4, v16
    s_lshr_b32 s13, s7, 1
    s_mul_i32 s13, s13, 320
    v_add_u32 v16, s13, v16
    v_add_u32 v17, 256, v16
    v_mov_b32 v15, 12416
    v_cmp_gt_u32 vcc, 32, v0
    v_lshlrev_b32 v253, 3, v0
    s_nop 0
    v_cndmask_b32 v17, v15, v17, vcc
    v_and_b32 v15, 12, v0
    v_cmp_eq_u32 vcc, 4, v15
    v_mov_b32 v15, 13568
    s_nop 0
    v_cndmask_b32 v16, v16, v15, vcc
    v_cndmask_b32 v17, v17, v15, vcc
    v_and_b32 v254, 2, v0
    v_lshlrev_b32 v254, 3, v254
    v_and_b32 v15, 12, v0
    v_add_u32 v254, v254, v15
    v_and_b32 v15, 0x31, v0
    v_cmp_eq_u32 vcc, 0, v15
    v_mov_b32 v15, 2130706432
    s_lshl_b32 s23, s6, 10
    s_lshl_b32 s13, s7, 5
    s_add_u32 s23, s23, s13
    s_lshl_b32 s13, s20, 8
    s_add_u32 s23, s23, s13
    v_cndmask_b32 v254, v15, v254, vcc
    s_setprio 3
    s_add_u32 s23, s23, 327680
    s_cmp_eq_u32 s5, 4
    s_cbranch_scc1 L_g
    s_branch L_q_bar
L_up_nom:
    s_waitcnt lgkmcnt(0)
    s_barrier
    v_mov_b32 v32, 0
    v_mov_b32 v33, 0
    v_mov_b32 v34, 0
    v_mov_b32 v35, 0
    v_mov_b32 v36, 0
    v_mov_b32 v37, 0
    v_mov_b32 v38, 0
    v_mov_b32 v39, 0
    v_mov_b32 v40, 0
    v_mov_b32 v41, 0
    v_mov_b32 v42, 0
    v_mov_b32 v43, 0
    v_mov_b32 v44, 0
    v_mov_b32 v45, 0
    v_mov_b32 v46, 0
    v_mov_b32 v47, 0
    v_mov_b32 v32, 0
    v_mov_b32 v33, 0
    v_mov_b32 v34, 0
    v_mov_b32 v35, 0
    v_mov_b32 v36, 0
    v_mov_b32 v37, 0
    v_mov_b32 v38, 0
    v_mov_b32 v39, 0
    v_mov_b32 v40, 0
    v_mov_b32 v41, 0
    v_mov_b32 v42, 0
    v_mov_b32 v43, 0
    v_mov_b32 v44, 0
    v_mov_b32 v45, 0
    v_mov_b32 v46, 0
    v_mov_b32 v47, 0
    s_branch L_xpub
L_last:
    s_add_u32 s13, s5, 24
    s_lshl_b32 s14, s3, 8
    s_or_b32 s14, s14, s41
    s_cmp_eq_u32 s13, s14
    s_cbranch_scc0 L_end
    s_cmp_lt_u32 s5, 5
    s_cbranch_scc0 L_end
    s_branch L_g
L_final2:
L_end:
L_exit:
    s_endpgm
L_q_prep0:
    s_sub_u32 s20, s5, 4
    v_lshlrev_b32 v14, 7, v1
    v_and_b32 v28, 12, v1
    v_lshl_add_u32 v14, v28, 3, v14
    v_and_b32 v28, 3, v0
    v_lshl_add_u32 v14, v28, 3, v14
    v_and_b32 v28, 32, v0
    v_lshl_add_u32 v14, v28, 6, v14
    s_lshl_b32 s13, s20, 5
    v_xor_b32 v14, s13, v14
    ds_read_b64_tr_b16 v[224:225], v14 offset:17408
    ds_read_b64_tr_b16 v[226:227], v14 offset:17664
    ds_read_b64_tr_b16 v[228:229], v14 offset:21504
    ds_read_b64_tr_b16 v[230:231], v14 offset:21760
    ds_read_b64_tr_b16 v[232:233], v14 offset:25600
    ds_read_b64_tr_b16 v[234:235], v14 offset:25856
    ds_read_b64_tr_b16 v[236:237], v14 offset:29696
    ds_read_b64_tr_b16 v[238:239], v14 offset:29952
    ds_read_b64_tr_b16 v[240:241], v14 offset:33792
    ds_read_b64_tr_b16 v[242:243], v14 offset:34048
    v_mov_b32 v244, 0
    v_mov_b32 v248, 0
    v_mov_b32 v245, 0
    v_mov_b32 v249, 0
    v_mov_b32 v246, 0
    v_mov_b32 v250, 0
    v_mov_b32 v247, 0
    v_mov_b32 v251, 0
    v_and_b32 v16, 48, v0
    v_and_b32 v15, 1, v0
    v_lshlrev_b32 v16, 1, v16
    v_lshl_add_u32 v16, v15, 4, v16
    s_lshr_b32 s13, s7, 1
    s_mul_i32 s13, s13, 320
    v_add_u32 v16, s13, v16
    v_add_u32 v17, 256, v16
    v_mov_b32 v15, 12416
    v_cmp_gt_u32 vcc, 32, v0
    v_lshlrev_b32 v253, 3, v0
    s_nop 0
    v_cndmask_b32 v17, v15, v17, vcc
    v_and_b32 v15, 12, v0
    v_cmp_eq_u32 vcc, 4, v15
    v_mov_b32 v15, 13568
    s_nop 0
    v_cndmask_b32 v16, v16, v15, vcc
    v_cndmask_b32 v17, v17, v15, vcc
    v_and_b32 v254, 2, v0
    v_lshlrev_b32 v254, 3, v254
    v_and_b32 v15, 12, v0
    v_add_u32 v254, v254, v15
    v_and_b32 v15, 0x31, v0
    v_cmp_eq_u32 vcc, 0, v15
    v_mov_b32 v15, 2130706432
    s_lshl_b32 s23, s6, 10
    s_lshl_b32 s13, s7, 5
    s_add_u32 s23, s23, s13
    s_lshl_b32 s13, s20, 8
    s_add_u32 s23, s23, s13
    v_cndmask_b32 v254, v15, v254, vcc
    s_setprio 3
    s_add_u32 s23, s23, 294912
    s_branch L_q_go
L_vland:
    s_waitcnt vmcnt(14)
    v_perm_b32 v128, v196, v192, s17
    v_perm_b32 v136, v196, v192, s18
    v_perm_b32 v144, v197, v193, s17
    v_perm_b32 v152, v197, v193, s18
    v_perm_b32 v160, v198, v194, s17
    v_perm_b32 v168, v198, v194, s18
    v_perm_b32 v176, v199, v195, s17
    v_perm_b32 v184, v199, v195, s18
    s_waitcnt vmcnt(12)
    v_perm_b32 v129, v204, v200, s17
    v_perm_b32 v137, v204, v200, s18
    v_perm_b32 v145, v205, v201, s17
    v_perm_b32 v153, v205, v201, s18
    v_perm_b32 v161, v206, v202, s17
    v_perm_b32 v169, v206, v202, s18
    v_perm_b32 v177, v207, v203, s17
    v_perm_b32 v185, v207, v203, s18
    s_waitcnt vmcnt(10)
    v_perm_b32 v130, v212, v208, s17
    v_perm_b32 v138, v212, v208, s18
    v_perm_b32 v146, v213, v209, s17
    v_perm_b32 v154, v213, v209, s18
    v_perm_b32 v162, v214, v210, s17
    v_perm_b32 v170, v214, v210, s18
    v_perm_b32 v178, v215, v211, s17
    v_perm_b32 v186, v215, v211, s18
    s_waitcnt vmcnt(8)
    v_perm_b32 v131, v220, v216, s17
    v_perm_b32 v139, v220, v216, s18
    v_perm_b32 v147, v221, v217, s17
    v_perm_b32 v155, v221, v217, s18
    v_perm_b32 v163, v222, v218, s17
    v_perm_b32 v171, v222, v218, s18
    v_perm_b32 v179, v223, v219, s17
    v_perm_b32 v187, v223, v219, s18
    v_mov_b32 v192, 0
    v_mov_b32 v194, 0
    v_mov_b32 v196, 0
    v_mov_b32 v198, 0
    v_mov_b32 v200, 0
    v_mov_b32 v202, 0
    v_mov_b32 v204, 0
    v_mov_b32 v206, 0
    v_mov_b32 v208, 0
    v_mov_b32 v210, 0
    v_mov_b32 v212, 0
    v_mov_b32 v214, 0
    v_mov_b32 v216, 0
    v_mov_b32 v218, 0
    v_mov_b32 v220, 0
    v_mov_b32 v222, 0
    s_waitcnt vmcnt(6)
    v_perm_b32 v132, v228, v224, s17
    v_perm_b32 v140, v228, v224, s18
    v_perm_b32 v148, v229, v225, s17
    v_perm_b32 v156, v229, v225, s18
    v_perm_b32 v164, v230, v226, s17
    v_perm_b32 v172, v230, v226, s18
    v_perm_b32 v180, v231, v227, s17
    v_perm_b32 v188, v231, v227, s18
    s_waitcnt vmcnt(4)
    v_perm_b32 v133, v236, v232, s17
    v_perm_b32 v141, v236, v232, s18
    v_perm_b32 v149, v237, v233, s17
    v_perm_b32 v157, v237, v233, s18
    v_perm_b32 v165, v238, v234, s17
    v_perm_b32 v173, v238, v234, s18
    v_perm_b32 v181, v239, v235, s17
    v_perm_b32 v189, v239, v235, s18
    s_waitcnt vmcnt(2)
    v_perm_b32 v134, v244, v240, s17
    v_perm_b32 v142, v244, v240, s18
    v_perm_b32 v150, v245, v241, s17
    v_perm_b32 v158, v245, v241, s18
    v_perm_b32 v166, v246, v242, s17
    v_perm_b32 v174, v246, v242, s18
    v_perm_b32 v182, v247, v243, s17
    v_perm_b32 v190, v247, v243, s18
    s_waitcnt vmcnt(0)
    v_perm_b32 v135, v252, v248, s17
    v_perm_b32 v143, v252, v248, s18
    v_perm_b32 v151, v253, v249, s17
    v_perm_b32 v159, v253, v249, s18
    v_perm_b32 v167, v254, v250, s17
    v_perm_b32 v175, v254, v250, s18
    v_perm_b32 v183, v255, v251, s17
    v_perm_b32 v191, v255, v251, s18
    s_nop 0
    s_branch L_pv
L_pfw:
    s_lshl_b32 s13, s3, 7
    s_add_u32 s13, s13, 146432
    s_mov_b32 s26, 1
    s_cmp_eq_u32 s5, 1
    s_waitcnt lgkmcnt(0)
    s_barrier
    s_cbranch_scc0 L_notk
    s_atomic_add s26, s[58:59], s13 glc
    s_waitcnt lgkmcnt(0)
    s_add_u32 s26, s26, 1
    s_min_u32 s26, s26, 31
    v_mov_b32 v28, s26
    v_mov_b32 v29, 0
    ds_write_b32 v29, v28 offset:15556
L_notk:
    v_mov_b32 v29, 0
L_rka:
    ds_read_b32 v28, v29 offset:15556
    s_waitcnt lgkmcnt(0)
    v_cmp_eq_u32 vcc, -1, v28
    s_cbranch_vccz L_rka_ok
    s_sub_u32 s12, s12, 1
    s_sleep 1
    s_cbranch_scc0 L_rka
    s_branch L_end
L_rka_ok:
    v_readfirstlane_b32 s41, v28
    s_cmp_eq_u32 s3, 7
    s_cselect_b32 s13, 20, 24
    s_cmp_lt_u32 s41, s13
    s_cselect_b32 s25, 1, 2
    s_cmp_lt_u32 s41, 10
    s_cselect_b32 s25, 0, s25
    s_lshl_b32 s86, s3, 13
    s_add_u32 s86, s86, 73216
    s_and_b32 s40, s3, 1
    s_mul_i32 s40, s40, 1280
    s_lshr_b32 s13, s3, 1
    s_lshl_b32 s13, s13, 14
    s_add_u32 s40, s40, s13
    s_xor_b32 s13, s84, 8192
    s_add_u32 s40, s40, s13
    s_lshl_b32 s13, s41, 7
    s_add_u32 s40, s40, s13
    s_add_u32 s40, s40, 65536
    s_lshl_b32 s13, s3, 13
    s_add_u32 s13, s13, s10
    s_lshl_b32 s15, s3, 7
    s_add_u32 s15, s15, s10
    s_add_u32 s15, s15, 145408
    s_cmp_lt_u32 s41, 2
    s_cselect_b32 s16, s5, 99
    s_cmp_eq_u32 s16, 3
    s_cselect_b32 s13, s13, 2130706432
    s_cselect_b32 s15, s15, 2130706432
    v_lshlrev_b32 v28, 7, v0
    buffer_load_dword v31, v28, s[68:71], s13 offen sc1
    buffer_load_dword v31, off, s[68:71], s15 sc1
    s_cmp_eq_u32 s25, 0
    s_cbranch_scc0 L_pf1
    v_lshrrev_b32 v20, 3, v0
    v_mul_u32_u24 v20, 1280, v20
    v_and_b32 v28, 0x70, v30
    v_and_b32 v29, 32, v0
    v_xor_b32 v28, v28, v29
    v_add_u32 v20, v20, v28
    v_xor_b32 v21, 64, v20
    s_lshl_b32 s13, s3, 9
    s_lshl_b32 s14, s5, 6
    s_add_u32 s13, s13, s14
    s_mul_i32 s13, s13, 1280
    s_lshl_b32 s14, s41, 7
    s_add_u32 s14, s13, s14
    s_lshl_b32 s16, s5, 13
    s_add_u32 m0, s16, 37888
    s_nop 0
    buffer_load_dwordx4 v20, s[76:79], s14 offen nt lds
    s_add_u32 m0, s16, 38912
    s_add_u32 s14, s14, 10240
    buffer_load_dwordx4 v21, s[76:79], s14 offen nt lds
    s_add_u32 m0, s16, 39936
    s_add_u32 s14, s14, 10240
    buffer_load_dwordx4 v20, s[76:79], s14 offen nt lds
    s_add_u32 m0, s16, 40960
    s_add_u32 s14, s14, 10240
    buffer_load_dwordx4 v21, s[76:79], s14 offen nt lds
    s_add_u32 m0, s16, 41984
    s_add_u32 s14, s14, 10240
    buffer_load_dwordx4 v20, s[76:79], s14 offen nt lds
    s_add_u32 m0, s16, 43008
    s_add_u32 s14, s14, 10240
    buffer_load_dwordx4 v21, s[76:79], s14 offen nt lds
    s_add_u32 m0, s16, 44032
    s_add_u32 s14, s14, 10240
    buffer_load_dwordx4 v20, s[76:79], s14 offen nt lds
    s_add_u32 m0, s16, 45056
    s_add_u32 s14, s14, 10240
    buffer_load_dwordx4 v21, s[76:79], s14 offen nt lds
    s_branch L_pfw_done
L_pf1:
    v_lshrrev_b32 v26, 2, v0
    v_mul_u32_u24 v26, 3456, v26
    v_and_b32 v28, 3, v0
    v_lshl_add_u32 v26, v28, 7, v26
    s_bitcmp1_b32 s41, 0
    s_cselect_b32 s92, s50, s48
    s_cselect_b32 s93, s51, s49
    s_and_b32 s93, s93, 0xffff
    s_sub_u32 s21, s41, 10
    s_lshr_b32 s21, s21, 1
    s_cmp_lt_u32 s21, 10
    s_mul_i32 s21, s21, 221184
    s_cselect_b32 s23, s21, 2130706432
    s_mul_i32 s21, s3, 7
    s_lshr_b32 s21, s21, 1
    s_lshl_b32 s21, s21, 7
    s_add_u32 s23, s23, s21
    v_add_u32 v26, s23, v26
    s_mul_i32 s23, s5, 55296
    s_cmp_lt_u32 s5, 1
    s_cselect_b32 s23, s23, 2130706432
    buffer_load_dword v31, v26, s[92:95], s23 offen
    s_branch L_pfw_done
L_pf2:
    s_mov_b32 s13, 55296
    buffer_load_dword v31, v26, s[92:95], s13 offen
    s_mov_b32 s13, 110592
    buffer_load_dword v31, v26, s[92:95], s13 offen
    s_mov_b32 s13, 165888
    buffer_load_dword v31, v26, s[92:95], s13 offen
    s_sub_u32 s14, s41, 24
    s_cmp_lt_u32 s14, 8
    s_cbranch_scc0 L_roles
    v_lshlrev_b32 v28, 7, v0
    s_mul_i32 s13, s3, 286720
    s_lshl_b32 s15, s14, 13
    s_add_u32 s13, s13, s15
    buffer_load_dword v31, v28, s[80:83], s13 offen
    s_add_u32 s13, s13, 65536
    buffer_load_dword v31, v28, s[80:83], s13 offen
    s_add_u32 s13, s13, 65536
    buffer_load_dword v31, v28, s[80:83], s13 offen
    s_add_u32 s13, s13, 65536
    buffer_load_dword v31, v28, s[80:83], s13 offen
    s_cmp_lt_u32 s14, 3
    s_cbranch_scc0 L_roles
    s_add_u32 s13, s13, 65536
    buffer_load_dword v31, v28, s[80:83], s13 offen
    s_branch L_roles
L_rank:
    v_mov_b32 v29, 0
L_rkb:
    ds_read_b32 v28, v29 offset:15556
    s_waitcnt lgkmcnt(0)
    v_cmp_eq_u32 vcc, -1, v28
    s_cbranch_vccz L_rkb_ok
    s_sub_u32 s12, s12, 1
    s_sleep 1
    s_cbranch_scc0 L_rkb
    s_branch L_end
L_rkb_ok:
    v_readfirstlane_b32 s41, v28
    s_cmp_eq_u32 s3, 7
    s_cselect_b32 s13, 20, 24
    s_cmp_lt_u32 s41, s13
    s_cselect_b32 s25, 1, 2
    s_cmp_lt_u32 s41, 10
    s_cselect_b32 s25, 0, s25
    s_lshl_b32 s86, s3, 13
    s_add_u32 s86, s86, 73216
    s_and_b32 s40, s3, 1
    s_mul_i32 s40, s40, 1280
    s_lshr_b32 s13, s3, 1
    s_lshl_b32 s13, s13, 14
    s_add_u32 s40, s40, s13
    s_xor_b32 s13, s84, 8192
    s_add_u32 s40, s40, s13
    s_lshl_b32 s13, s41, 7
    s_add_u32 s40, s40, s13
    s_add_u32 s40, s40, 65536
    s_branch L_roles
L_up0:
    s_cmp_eq_u32 s5, 4
    s_cbranch_scc1 L_g
    s_waitcnt vmcnt(0)
L_try0:
L_hook:
    s_waitcnt vmcnt(1)
    s_barrier
    s_cmp_ge_u32 s5, 4
    s_cbranch_scc0 L_fgo
    ds_read_b64_tr_b16 v[192:193], v14 offset:0
    ds_read_b64_tr_b16 v[194:195], v17 offset:0
    ds_read_b64_tr_b16 v[196:197], v14 offset:4096
    ds_read_b64_tr_b16 v[198:199], v17 offset:4096
    ds_read_b64_tr_b16 v[200:201], v14 offset:8192
    ds_read_b64_tr_b16 v[202:203], v17 offset:8192
    ds_read_b64_tr_b16 v[204:205], v14 offset:12288
    ds_read_b64_tr_b16 v[206:207], v17 offset:12288
    ds_read_b64_tr_b16 v[208:209], v14 offset:16384
    ds_read_b64_tr_b16 v[210:211], v17 offset:16384
    ds_read_b64_tr_b16 v[212:213], v14 offset:20480
    ds_read_b64_tr_b16 v[214:215], v17 offset:20480
    ds_read_b64_tr_b16 v[216:217], v14 offset:24576
    ds_read_b64_tr_b16 v[218:219], v17 offset:24576
    ds_read_b64_tr_b16 v[220:221], v14 offset:28672
    ds_read_b64_tr_b16 v[222:223], v17 offset:28672
    ds_read_b64_tr_b16 v[224:225], v14 offset:32768
    ds_read_b64_tr_b16 v[226:227], v17 offset:32768
    ds_read_b64_tr_b16 v[228:229], v14 offset:36864
    ds_read_b64_tr_b16 v[230:231], v17 offset:36864
    s_cmp_eq_u32 s5, 4
    s_cbranch_scc0 L_up_bar
    s_branch L_fgo
L_wo_dma:
    s_cmp_lt_u32 s5, 4
    s_cbranch_scc1 L_wo_iss
    v_lshrrev_b32 v20, 3, v0
    v_mul_u32_u24 v20, 1280, v20
    v_and_b32 v28, 0x70, v30
    v_and_b32 v29, 32, v0
    v_xor_b32 v28, v28, v29
    v_add_u32 v20, v20, v28
    v_xor_b32 v21, 64, v20
    s_lshl_b32 s13, s3, 9
    s_lshl_b32 s14, s5, 6
    s_add_u32 s13, s13, s14
    s_mul_i32 s13, s13, 1280
    s_lshl_b32 s14, s41, 7
    s_add_u32 s14, s13, s14
    s_lshl_b32 s16, s5, 13
    s_add_u32 m0, s16, 37888
    s_nop 0
    buffer_load_dwordx4 v20, s[76:79], s14 offen nt lds
    s_add_u32 m0, s16, 38912
    s_add_u32 s14, s14, 10240
    buffer_load_dwordx4 v21, s[76:79], s14 offen nt lds
    s_add_u32 m0, s16, 39936
    s_add_u32 s14, s14, 10240
    buffer_load_dwordx4 v20, s[76:79], s14 offen nt lds
    s_add_u32 m0, s16, 40960
    s_add_u32 s14, s14, 10240
    buffer_load_dwordx4 v21, s[76:79], s14 offen nt lds
    s_add_u32 m0, s16, 41984
    s_add_u32 s14, s14, 10240
    buffer_load_dwordx4 v20, s[76:79], s14 offen nt lds
    s_add_u32 m0, s16, 43008
    s_add_u32 s14, s14, 10240
    buffer_load_dwordx4 v21, s[76:79], s14 offen nt lds
    s_add_u32 m0, s16, 44032
    s_add_u32 s14, s14, 10240
    buffer_load_dwordx4 v20, s[76:79], s14 offen nt lds
    s_add_u32 m0, s16, 45056
    s_add_u32 s14, s14, 10240
    buffer_load_dwordx4 v21, s[76:79], s14 offen nt lds
L_wo_iss:
    v_lshlrev_b32 v20, 7, v1
    v_and_b32 v28, 12, v1
    v_lshl_add_u32 v20, v28, 3, v20
    v_and_b32 v28, 3, v0
    v_lshl_add_u32 v20, v28, 3, v20
    v_and_b32 v28, 32, v0
    v_lshl_add_u32 v20, v28, 6, v20
    s_lshl_b32 s13, s5, 13
    s_add_u32 s13, s13, 37888
    v_add_u32 v20, s13, v20
    v_xor_b32 v21, 32, v20
    v_xor_b32 v22, 64, v20
    v_xor_b32 v23, 96, v20
    s_waitcnt vmcnt(0)
    ds_read_b64_tr_b16 v[224:225], v20 offset:0
    ds_read_b64_tr_b16 v[226:227], v20 offset:256
    ds_read_b64_tr_b16 v[228:229], v20 offset:4096
    ds_read_b64_tr_b16 v[230:231], v20 offset:4352
    ds_read_b64_tr_b16 v[240:241], v22 offset:0
    ds_read_b64_tr_b16 v[242:243], v22 offset:256
    ds_read_b64_tr_b16 v[244:245], v22 offset:4096
    ds_read_b64_tr_b16 v[246:247], v22 offset:4352
    ds_read_b64_tr_b16 v[232:233], v21 offset:0
    ds_read_b64_tr_b16 v[234:235], v21 offset:256
    ds_read_b64_tr_b16 v[236:237], v21 offset:4096
    ds_read_b64_tr_b16 v[238:239], v21 offset:4352
    ds_read_b64_tr_b16 v[248:249], v23 offset:0
    ds_read_b64_tr_b16 v[250:251], v23 offset:256
    ds_read_b64_tr_b16 v[252:253], v23 offset:4096
    ds_read_b64_tr_b16 v[254:255], v23 offset:4352
    s_branch L_wo_have
L_q_st_slow:
    s_cmp_eq_u32 s9, 0
    s_cbranch_scc0 L_q_st1
    s_load_dword s26, s[56:57], 128
    s_waitcnt lgkmcnt(0)
    s_cmp_eq_u32 s26, 0
    s_cbranch_scc0 L_gom_ok
    s_sub_u32 s12, s12, 1
    s_sleep 12
    s_load_dword s26, s[56:57], 192
    s_waitcnt lgkmcnt(0)
    s_cmp_eq_u32 s26, 0
    s_cbranch_scc0 L_gom_ok
    s_sub_u32 s12, s12, 1
    s_sleep 12
    s_load_dword s26, s[56:57], 64
    s_waitcnt lgkmcnt(0)
    s_cmp_eq_u32 s26, 0
    s_cbranch_scc0 L_gom_ok
L_gom:
    s_sub_u32 s12, s12, 1
    s_cbranch_scc1 L_end
    v_mov_b32 v28, 0
    global_load_dword v28, v28, s[56:57] offset:128 sc1
    s_waitcnt vmcnt(0)
    v_readfirstlane_b32 s26, v28
    s_cmp_eq_u32 s26, 0
    s_cbranch_scc1 L_gom
L_gom_ok:
    s_cmp_eq_u32 s5, 4
    s_cbranch_scc0 L_q_st1
    s_getreg_b32 s13, hwreg(HW_REG_XCC_ID, 0, 4)
    v_mov_b32 v15, s13
    s_lshl_b32 s13, s3, 5
    s_add_u32 s13, s13, s4
    s_lshl_b32 s13, s13, 5
    s_add_u32 s13, s13, 360448
    s_mov_b64 exec, 1
    buffer_store_dword v15, off, s[68:71], s13 sc1
    s_mov_b64 exec, -1
L_q_st1:
    buffer_store_dword v35, v254, s[68:71], s23 offen sc1
    s_branch L_q_st_done
L_a_st_slow:
    buffer_store_dword v17, off, s[68:71], s37 sc1
    s_branch L_a_st_done
L_o_st_slow:
    buffer_store_dword v20, v24, s[68:71], s36 offen sc1
    s_branch L_o_st_done
L_yf_slow:
    buffer_store_dword v0, v28, s[68:71], s13 offen sc1
    s_branch L_yf_done
L_h_st_slow:
    buffer_store_dword v35, v25, s[68:71], s23 offen sc1
    s_branch L_h_st_done
L_x_st_slow:
    buffer_store_dword v45, v5, s[68:71], s21 offen sc1
    s_branch L_x_st_done
L_code_end:
.section .rodata,"a"
.p2align 6
.amdhsa_kernel interleave_layers__mha_block_cached__glu_gated_swiglu__decode_kernel
  .amdhsa_next_free_vgpr 256
  .amdhsa_next_free_sgpr 102
  .amdhsa_accum_offset 256
  .amdhsa_group_segment_fixed_size 0
  .amdhsa_kernarg_size 96
  .amdhsa_user_sgpr_count 2
  .amdhsa_user_sgpr_kernarg_segment_ptr 1
  .amdhsa_system_sgpr_workgroup_id_x 1
  .amdhsa_float_denorm_mode_32 3
.end_amdhsa_kernel
```
